```python
import torch

def _softmax(x, axis=-1):
    return torch.softmax(x, dim=axis)
def _gelu(x):
    return torch.nn.functional.gelu(x, approximate="tanh")
def _silu(x):
    return torch.nn.functional.silu(x)
def _sigmoid(x):
    return torch.sigmoid(x)
def _layernorm(x, axis=-1, eps=1e-5):
    m = x.mean(dim=axis, keepdim=True)
    v = x.var(dim=axis, keepdim=True, unbiased=False)
    return (x - m) / torch.sqrt(v + eps)
def _scatter_add(tgt, idx, src, axis=0):
    return tgt.clone().index_add_(axis, idx, src)
def _segment_sum(src, seg, n):
    out = torch.zeros((n,) + src.shape[1:], dtype=src.dtype)
    return out.index_add_(0, seg, src)
def _pad(x, pw):
    flat = tuple(v for pair in reversed(pw) for v in pair)
    return torch.nn.functional.pad(x, flat)

kernel_name = 'concat_heads__sliding_local_dilated__ssm_conv_h3__prompt'

def setup_inputs():

    _w = (lambda a: (lambda t: t.to(torch.bfloat16) if t.is_floating_point() else t)(torch.as_tensor(a)))
    def _A_setup():
        B, S, D = 1, 2048, 576
        return {
            "x": _w((lambda *s: torch.randn(*s, dtype=torch.bfloat16) * 0.2)(B, S, D)),
            "wqkv": _w((lambda *s: torch.randn(*s, dtype=torch.bfloat16) * 0.2)(D, 3 * D)),
            "wo": _w((lambda *s: torch.randn(*s, dtype=torch.bfloat16) * 0.05)(D, D)),
        }
    _A_in = _A_setup()

    def _B_setup():
        B, S, D = 1, 2048, 576
        ks = 4
        return {
            "q": _w((lambda *s: torch.randn(*s, dtype=torch.bfloat16) * 0.05)(B, S, D)),
            "k": _w((lambda *s: torch.randn(*s, dtype=torch.bfloat16) * 0.8)(B, S, D)),
            "v": _w((lambda *s: torch.randn(*s, dtype=torch.bfloat16) * 0.8)(B, S, D)),
            "shift_k": _w((lambda *s: torch.randn(*s, dtype=torch.bfloat16) * 0.8)(D, ks) * 0.5),
            "ssm_k": _w((lambda *s: torch.randn(*s, dtype=torch.bfloat16) * 3.2)(D, S) * (1.0 / S ** 0.5)),
            "ssm_D": _w((lambda *s: torch.randn(*s, dtype=torch.bfloat16) * 0.8)(D)),
        }
    _B_in = _B_setup()

    return {
        "A_x": _A_in["x"],
        "A_wqkv": _A_in["wqkv"],
        "A_wo": _A_in["wo"],
        "B_q": _B_in["q"],
        "B_k": _B_in["k"],
        "B_v": _B_in["v"],
        "B_shift_k": _B_in["shift_k"],
        "B_ssm_k": _B_in["ssm_k"],
        "B_ssm_D": _B_in["ssm_D"],
    }

def reference(A_x, A_wqkv, A_wo, B_q, B_k, B_v, B_shift_k, B_ssm_k, B_ssm_D):
    def _A_ref(x, wqkv, wo):
        B, S, D = x.shape
        H = 32; Dh = D // H
        W, dil = 8, 2
        qkv = (lambda x, *d: x.permute(*d))((x @ wqkv).reshape(B, S, 3, H, Dh), 2, 0, 3, 1, 4)
        q, k, v = qkv[0], qkv[1], qkv[2]
        scale = Dh ** -0.5
        pos = torch.arange(S)
        off = torch.arange(W) * dil
        idx = pos[:, None] - off[None, :]
        mask = idx >= 0
        idx_c = torch.where(mask, idx, 0).reshape(-1)
        kg = k[:, :, idx_c, :].reshape(B, H, S, W, Dh)
        vg = v[:, :, idx_c, :].reshape(B, H, S, W, Dh)
        logits = torch.einsum("bhsd,bhswd->bhsw", q, kg) * scale
        logits = torch.where(mask[None, None, :, :], logits, -1e9)
        attn = _softmax(logits, axis=-1)
        o = torch.einsum("bhsw,bhswd->bhsd", attn, vg)
        return (lambda x, *d: x.permute(*d))(o, 0, 2, 1, 3).reshape(B, S, D) @ wo

    def _B_ref(q, k, v, shift_k, ssm_k, ssm_D):
        B, S, D = q.shape
        ks = shift_k.shape[-1]
        k_pad = _pad(k, ((0, 0), (ks - 1, 0), (0, 0)))
        k_shift = torch.zeros_like(k)
        for t in range(ks):
            k_shift = k_shift + k_pad[:, t:t + S, :] * shift_k[:, ks - 1 - t][None, None, :]
        kv = k_shift * v
        L = 2 * S
        kv_pad = _pad(kv, ((0, 0), (0, S), (0, 0)))
        kf_pad = _pad(ssm_k, ((0, 0), (0, S)))
        kv_f = (lambda x, axes=(-2,-1): torch.fft.rfft2(x.float(), dim=axes))(kv_pad[:, None, :, :], axes=(1, 2))
        kf_f = (lambda x, axes=(-2,-1): torch.fft.rfft2(x.float(), dim=axes))(kf_pad[:, None, :], axes=(1, 2))
        kf_f = (lambda x, *d: x.permute(*d))(kf_f, 1, 2, 0)
        y_f = kv_f * kf_f[None, :, :, :]
        y = (lambda x, s, axes=(-2,-1): torch.fft.irfft2(x, s=s, dim=axes).to(torch.bfloat16))(y_f, (1, L), axes=(1, 2))[:, 0, :S, :]
        y = y + kv * ssm_D[None, None, :]
        return q * y

    a = _A_ref(A_x, A_wqkv, A_wo)
    b = _B_ref(B_q, B_k, B_v, B_shift_k, B_ssm_k, B_ssm_D)
    return torch.concatenate([a, b], axis=-1)
```

```asm
; @launch grid=(256,1,1) block=(512,1,1) lds=163840
.amdgcn_target "amdgcn-amd-amdhsa--gfx950"
.text
.globl concat_heads__sliding_local_dilated__ssm_conv_h3__prompt_kernel
.p2align 8
.type concat_heads__sliding_local_dilated__ssm_conv_h3__prompt_kernel,@function
concat_heads__sliding_local_dilated__ssm_conv_h3__prompt_kernel:
    s_load_dwordx16 s[16:31], s[0:1], 0
    s_load_dwordx8 s[32:39], s[0:1], 64
    s_cmp_ge_u32 s2, 176
    s_cbranch_scc1 F_NOTA
    v_lshrrev_b32 v1, 6, v0
    v_and_b32 v2, 63, v0
    s_and_b32 s8, s2, 7
    v_readfirstlane_b32 s6, v1
    s_lshr_b32 s9, s2, 3
    s_lshr_b32 s4, s8, 1
    s_mul_i32 s4, s4, 22
    s_add_u32 s10, s4, s9
    s_lshr_b32 s4, s10, 3
    s_and_b32 s5, s8, 1
    s_lshl_b32 s5, s5, 3
    s_and_b32 s10, s10, 7
    s_add_u32 s5, s5, s10
    s_cmp_lt_u32 s6, 4
    s_cbranch_scc1 A1_CONS
A1_LOADER:
    s_sub_u32 s3, s6, 4
    v_lshrrev_b32 v30, 3, v2
    s_lshl_b32 s8, s3, 3
    v_add_u32 v30, s8, v30
    v_bfe_u32 v31, v30, 1, 3
    v_and_b32 v32, 7, v2
    v_xor_b32 v31, v31, v32
    v_lshlrev_b32 v31, 4, v31
    s_mul_i32 s8, s4, 192
    s_sub_i32 s8, s8, 16
    v_add_u32 v30, s8, v30
    v_mul_i32_i24 v6, 1152, v30
    v_add_u32 v6, v6, v31
    v_max_i32 v30, 0, v30
    v_mul_u32_u24 v10, 1152, v30
    v_add_u32 v10, v10, v31
    v_add_u32 v11, 36864, v6
    v_add_u32 v12, 73728, v6
    v_add_u32 v13, 110592, v6
    v_add_u32 v14, 147456, v6
    v_add_u32 v15, 184320, v6
    v_add_u32 v16, 221184, v6
    v_lshrrev_b32 v30, 4, v2
    s_lshl_b32 s9, s3, 2
    v_add_u32 v30, s9, v30
    v_and_b32 v31, 15, v2
    v_and_b32 v32, 14, v30
    v_sub_u32 v31, v31, v32
    v_and_b32 v31, 15, v31
    v_mul_u32_u24 v32, 52, v31
    v_lshrrev_b32 v32, 8, v32
    v_min_u32 v32, 2, v32
    v_mul_u32_u24 v33, 5, v32
    v_sub_u32 v33, v31, v33
    v_min_u32 v33, 4, v33
    v_lshlrev_b32 v36, 4, v33
    v_lshrrev_b32 v37, 2, v33
    v_lshlrev_b32 v37, 3, v37
    v_sub_u32 v36, v36, v37
    v_and_b32 v34, 8, v30
    v_and_b32 v35, 1, v30
    v_lshl_or_b32 v34, v35, 2, v34
    v_bfe_u32 v35, v30, 1, 2
    v_or_b32 v34, v34, v35
    v_mul_u32_u24 v7, 3456, v34
    v_add_u32 v7, v36, v7
    v_add_u32 v33, 1, v32
    v_mul_u32_u24 v33, 1152, v33
    v_cmp_eq_u32 vcc, 2, v32
    s_mul_i32 s10, s5, 72
    s_lshl_b32 s14, s3, 10
    v_cndmask_b32_e64 v33, v33, 0, vcc
    v_add3_u32 v20, v7, v33, s10
    v_add_u32 v21, 55296, v20
    v_add_u32 v22, 110592, v20
    v_add_u32 v23, 165888, v20
    s_and_b32 s9, s5, 7
    s_lshl_b32 s12, s4, 2
    s_add_u32 s9, s9, s12
    s_mul_i32 s12, s9, 57
    s_lshr_b32 s12, s12, 9
    s_mul_i32 s12, s12, 9
    s_sub_u32 s12, s9, s12
    s_lshl_b32 s13, s12, 7
    s_mul_i32 s12, s12, 221184
    s_add_u32 s15, s14, 26624
    s_waitcnt lgkmcnt(0)
    s_mov_b32 s40, s16
    s_and_b32 s41, s17, 0xffff
    s_mov_b32 s42, 2359296
    s_mov_b32 s43, 0x00020000
    s_mov_b32 s44, s18
    s_and_b32 s45, s19, 0xffff
    s_mov_b32 s46, 1990656
    s_mov_b32 s47, 0x00020000
    s_cmp_lg_u32 s2, 0
    s_cbranch_scc1 Ltagskip_1
    s_cmp_lg_u32 s6, 4
    s_cbranch_scc1 Ltagskip_1
    s_memrealtime s[60:61]
    s_mov_b32 s56, s36
    s_and_b32 s57, s37, 0xffff
    s_mov_b32 s58, 256
    s_mov_b32 s59, 0x00020000
    s_waitcnt lgkmcnt(0)
    s_or_b32 s60, s60, 1
    v_mov_b32 v250, s60
    v_mov_b32 v251, s61
    v_mov_b32 v252, 248
    s_mov_b64 s[62:63], exec
    s_mov_b64 exec, 1
    buffer_store_dwordx2 v[250:251], v252, s[56:59], 0 offen sc1
    s_mov_b64 exec, s[62:63]
Ltagskip_1:
    s_mov_b32 s7, -2
    s_mov_b32 s11, 0
A1_LLOOP:
    s_cmp_lt_i32 s7, 0
    s_cbranch_scc1 A1_LISS
    s_waitcnt vmcnt(10)
    s_cmp_lt_i32 s7, 8
    s_cbranch_scc1 A1_LB
    s_waitcnt vmcnt(0)
A1_LB:
    s_barrier
    s_cmp_ge_i32 s7, 7
    s_cbranch_scc1 A1_LNEXT
A1_LISS:
    s_add_u32 m0, s15, s11
    s_nop 0
    buffer_load_dwordx4 v20, s[44:47], s12 offen lds
    s_addk_i32 m0, 4096
    s_nop 0
    buffer_load_dwordx4 v21, s[44:47], s12 offen lds
    s_addk_i32 m0, 4096
    s_nop 0
    buffer_load_dwordx4 v22, s[44:47], s12 offen lds
    s_addk_i32 m0, 4096
    s_nop 0
    buffer_load_dwordx4 v23, s[44:47], s12 offen lds
    s_add_u32 m0, s14, s11
    s_add_u32 s12, s12, 221184
    buffer_load_dwordx4 v10, s[40:43], s13 offen lds
    s_addk_i32 m0, 4096
    s_nop 0
    buffer_load_dwordx4 v11, s[40:43], s13 offen lds
    s_addk_i32 m0, 4096
    s_nop 0
    buffer_load_dwordx4 v12, s[40:43], s13 offen lds
    s_addk_i32 m0, 4096
    s_nop 0
    buffer_load_dwordx4 v13, s[40:43], s13 offen lds
    s_addk_i32 m0, 4096
    s_nop 0
    buffer_load_dwordx4 v14, s[40:43], s13 offen lds
    s_addk_i32 m0, 4096
    s_nop 0
    buffer_load_dwordx4 v15, s[40:43], s13 offen lds
    s_cmp_ge_u32 s3, 2
    s_cbranch_scc1 A1_LXS
    s_addk_i32 m0, 4096
    s_nop 0
    buffer_load_dwordx4 v16, s[40:43], s13 offen lds
A1_LXS:
    s_addk_i32 s13, 128
    s_cmp_eq_u32 s13, 1152
    s_cselect_b32 s13, 0, s13
    s_cselect_b32 s12, 0, s12
    s_add_u32 s11, s11, 43008
    s_cmp_eq_u32 s11, 129024
    s_cselect_b32 s11, 0, s11
A1_LNEXT:
    s_add_i32 s7, s7, 1
    s_cmp_lt_i32 s7, 9
    s_cbranch_scc1 A1_LLOOP
    s_branch A1_JOIN
A1_CONS:
    v_and_b32 v3, 15, v2
    v_lshrrev_b32 v4, 4, v2
    v_bfe_u32 v12, v3, 1, 3
    v_xor_b32 v12, v12, v4
    v_lshlrev_b32 v13, 7, v3
    v_lshl_add_u32 v21, v12, 4, v13
    v_xor_b32 v22, 64, v21
    s_mul_i32 s8, s6, 6144
    s_add_u32 s8, s8, 2048
    v_add_u32 v19, s8, v21
    v_add_u32 v20, s8, v22
    v_bfe_u32 v30, v2, 2, 2
    v_and_b32 v31, 3, v2
    v_lshlrev_b32 v32, 3, v4
    v_lshl_add_u32 v32, v30, 1, v32
    v_lshlrev_b32 v32, 8, v32
    v_add_u32 v32, 26624, v32
    v_and_b32 v33, 1, v4
    v_lshl_add_u32 v33, v33, 2, v30
    v_lshlrev_b32 v33, 5, v33
    v_mul_u32_u24 v34, 272, v3
    s_mov_b32 s56, s6
    s_mov_b32 s57, 4
    s_add_u32 s58, s6, 1
    s_and_b32 s58, s58, 3
    s_add_u32 s59, s6, 2
    s_and_b32 s59, s59, 3
    s_add_u32 s60, s6, 3
    s_and_b32 s60, s60, 3
    s_mov_b32 s61, 5
    s_mov_b32 s62, 6
    s_lshl_b32 s8, s56, 2
    v_add_u32 v35, s8, v31
    v_mul_u32_u24 v36, 57, v35
    v_lshrrev_b32 v36, 9, v36
    v_mul_u32_u24 v37, 9, v36
    v_sub_u32 v37, v35, v37
    v_lshrrev_b32 v37, 3, v37
    v_add3_u32 v36, v36, v35, v37
    v_lshl_add_u32 v36, v36, 3, v33
    v_and_b32 v36, 255, v36
    v_add_u32 v23, v36, v32
    v_add_u32 v35, s8, v4
    v_mul_u32_u24 v36, 57, v35
    v_lshrrev_b32 v36, 9, v36
    v_mul_u32_u24 v37, 9, v36
    v_sub_u32 v37, v35, v37
    v_mul_u32_u24 v37, 13, v37
    v_lshrrev_b32 v37, 6, v37
    v_add3_u32 v37, v37, v36, v35
    v_lshl_add_u32 v8, v37, 3, v34
    s_lshl_b32 s8, s57, 2
    v_add_u32 v35, s8, v31
    v_mul_u32_u24 v36, 57, v35
    v_lshrrev_b32 v36, 9, v36
    v_mul_u32_u24 v37, 9, v36
    v_sub_u32 v37, v35, v37
    v_lshrrev_b32 v37, 3, v37
    v_add3_u32 v36, v36, v35, v37
    v_lshl_add_u32 v36, v36, 3, v33
    v_and_b32 v36, 255, v36
    v_add_u32 v24, v36, v32
    v_add_u32 v35, s8, v4
    v_mul_u32_u24 v36, 57, v35
    v_lshrrev_b32 v36, 9, v36
    v_mul_u32_u24 v37, 9, v36
    v_sub_u32 v37, v35, v37
    v_mul_u32_u24 v37, 13, v37
    v_lshrrev_b32 v37, 6, v37
    v_add3_u32 v37, v37, v36, v35
    v_lshl_add_u32 v9, v37, 3, v34
    s_lshl_b32 s8, s58, 2
    v_add_u32 v35, s8, v31
    v_mul_u32_u24 v36, 57, v35
    v_lshrrev_b32 v36, 9, v36
    v_mul_u32_u24 v37, 9, v36
    v_sub_u32 v37, v35, v37
    v_lshrrev_b32 v37, 3, v37
    v_add3_u32 v36, v36, v35, v37
    v_lshl_add_u32 v36, v36, 3, v33
    v_and_b32 v36, 255, v36
    v_add_u32 v25, v36, v32
    v_add_u32 v35, s8, v4
    v_mul_u32_u24 v36, 57, v35
    v_lshrrev_b32 v36, 9, v36
    v_mul_u32_u24 v37, 9, v36
    v_sub_u32 v37, v35, v37
    v_mul_u32_u24 v37, 13, v37
    v_lshrrev_b32 v37, 6, v37
    v_add3_u32 v37, v37, v36, v35
    v_lshl_add_u32 v10, v37, 3, v34
    s_lshl_b32 s8, s59, 2
    v_add_u32 v35, s8, v31
    v_mul_u32_u24 v36, 57, v35
    v_lshrrev_b32 v36, 9, v36
    v_mul_u32_u24 v37, 9, v36
    v_sub_u32 v37, v35, v37
    v_lshrrev_b32 v37, 3, v37
    v_add3_u32 v36, v36, v35, v37
    v_lshl_add_u32 v36, v36, 3, v33
    v_and_b32 v36, 255, v36
    v_add_u32 v26, v36, v32
    v_add_u32 v35, s8, v4
    v_mul_u32_u24 v36, 57, v35
    v_lshrrev_b32 v36, 9, v36
    v_mul_u32_u24 v37, 9, v36
    v_sub_u32 v37, v35, v37
    v_mul_u32_u24 v37, 13, v37
    v_lshrrev_b32 v37, 6, v37
    v_add3_u32 v37, v37, v36, v35
    v_lshl_add_u32 v11, v37, 3, v34
    s_lshl_b32 s8, s60, 2
    v_add_u32 v35, s8, v31
    v_mul_u32_u24 v36, 57, v35
    v_lshrrev_b32 v36, 9, v36
    v_mul_u32_u24 v37, 9, v36
    v_sub_u32 v37, v35, v37
    v_lshrrev_b32 v37, 3, v37
    v_add3_u32 v36, v36, v35, v37
    v_lshl_add_u32 v36, v36, 3, v33
    v_and_b32 v36, 255, v36
    v_add_u32 v27, v36, v32
    v_add_u32 v35, s8, v4
    v_mul_u32_u24 v36, 57, v35
    v_lshrrev_b32 v36, 9, v36
    v_mul_u32_u24 v37, 9, v36
    v_sub_u32 v37, v35, v37
    v_mul_u32_u24 v37, 13, v37
    v_lshrrev_b32 v37, 6, v37
    v_add3_u32 v37, v37, v36, v35
    v_lshl_add_u32 v12, v37, 3, v34
    s_lshl_b32 s8, s61, 2
    v_add_u32 v35, s8, v31
    v_mul_u32_u24 v36, 57, v35
    v_lshrrev_b32 v36, 9, v36
    v_mul_u32_u24 v37, 9, v36
    v_sub_u32 v37, v35, v37
    v_lshrrev_b32 v37, 3, v37
    v_add3_u32 v36, v36, v35, v37
    v_lshl_add_u32 v36, v36, 3, v33
    v_and_b32 v36, 255, v36
    v_add_u32 v28, v36, v32
    v_add_u32 v35, s8, v4
    v_mul_u32_u24 v36, 57, v35
    v_lshrrev_b32 v36, 9, v36
    v_mul_u32_u24 v37, 9, v36
    v_sub_u32 v37, v35, v37
    v_mul_u32_u24 v37, 13, v37
    v_lshrrev_b32 v37, 6, v37
    v_add3_u32 v37, v37, v36, v35
    v_lshl_add_u32 v13, v37, 3, v34
    s_lshl_b32 s8, s62, 2
    v_add_u32 v35, s8, v31
    v_min_u32 v35, 26, v35
    v_mul_u32_u24 v36, 57, v35
    v_lshrrev_b32 v36, 9, v36
    v_mul_u32_u24 v37, 9, v36
    v_sub_u32 v37, v35, v37
    v_lshrrev_b32 v37, 3, v37
    v_add3_u32 v36, v36, v35, v37
    v_lshl_add_u32 v36, v36, 3, v33
    v_and_b32 v36, 255, v36
    v_add_u32 v29, v36, v32
    v_add_u32 v35, s8, v4
    v_mul_u32_u24 v36, 57, v35
    v_lshrrev_b32 v36, 9, v36
    v_min_u32 v36, 2, v36
    v_mul_u32_u24 v37, 9, v36
    v_sub_u32 v37, v35, v37
    v_mul_u32_u24 v37, 13, v37
    v_lshrrev_b32 v37, 6, v37
    v_add3_u32 v37, v37, v36, v35
    v_lshl_add_u32 v14, v37, 3, v34
    v_mov_b32 v32, 0
    v_mov_b32 v33, 0
    v_mov_b32 v34, 0
    v_mov_b32 v35, 0
    v_mov_b32 v36, 0
    v_mov_b32 v37, 0
    v_mov_b32 v38, 0
    v_mov_b32 v39, 0
    v_mov_b32 v40, 0
    v_mov_b32 v41, 0
    v_mov_b32 v42, 0
    v_mov_b32 v43, 0
    v_mov_b32 v44, 0
    v_mov_b32 v45, 0
    v_mov_b32 v46, 0
    v_mov_b32 v47, 0
    v_mov_b32 v48, 0
    v_mov_b32 v49, 0
    v_mov_b32 v50, 0
    v_mov_b32 v51, 0
    v_mov_b32 v52, 0
    v_mov_b32 v53, 0
    v_mov_b32 v54, 0
    v_mov_b32 v55, 0
    v_mov_b32 v56, 0
    v_mov_b32 v57, 0
    v_mov_b32 v58, 0
    v_mov_b32 v59, 0
    v_mov_b32 v60, 0
    v_mov_b32 v61, 0
    v_mov_b32 v62, 0
    v_mov_b32 v63, 0
    v_mov_b32 v64, 0
    v_mov_b32 v65, 0
    v_mov_b32 v66, 0
    v_mov_b32 v67, 0
    v_mov_b32 v68, 0
    v_mov_b32 v69, 0
    v_mov_b32 v70, 0
    v_mov_b32 v71, 0
    v_mov_b32 v72, 0
    v_mov_b32 v73, 0
    v_mov_b32 v74, 0
    v_mov_b32 v75, 0
    v_mov_b32 v76, 0
    v_mov_b32 v77, 0
    v_mov_b32 v78, 0
    v_mov_b32 v79, 0
    v_mov_b32 v80, 0
    v_mov_b32 v81, 0
    v_mov_b32 v82, 0
    v_mov_b32 v83, 0
    v_mov_b32 v84, 0
    v_mov_b32 v85, 0
    v_mov_b32 v86, 0
    v_mov_b32 v87, 0
    v_mov_b32 v88, 0
    v_mov_b32 v89, 0
    v_mov_b32 v90, 0
    v_mov_b32 v91, 0
    v_mov_b32 v92, 0
    v_mov_b32 v93, 0
    v_mov_b32 v94, 0
    v_mov_b32 v95, 0
    v_mov_b32 v96, 0
    v_mov_b32 v97, 0
    v_mov_b32 v98, 0
    v_mov_b32 v99, 0
    v_mov_b32 v100, 0
    v_mov_b32 v101, 0
    v_mov_b32 v102, 0
    v_mov_b32 v103, 0
    v_mov_b32 v104, 0
    v_mov_b32 v105, 0
    v_mov_b32 v106, 0
    v_mov_b32 v107, 0
    v_mov_b32 v108, 0
    v_mov_b32 v109, 0
    v_mov_b32 v110, 0
    v_mov_b32 v111, 0
    v_mov_b32 v112, 0
    v_mov_b32 v113, 0
    v_mov_b32 v114, 0
    v_mov_b32 v115, 0
    v_mov_b32 v116, 0
    v_mov_b32 v117, 0
    v_mov_b32 v118, 0
    v_mov_b32 v119, 0
    v_mov_b32 v120, 0
    v_mov_b32 v121, 0
    v_mov_b32 v122, 0
    v_mov_b32 v123, 0
    s_mov_b32 s7, 0
    s_mov_b32 s10, 0
    s_barrier
    ds_read_b128 v[180:183], v19 offset:0
    ds_read_b128 v[184:187], v19 offset:2048
    ds_read_b128 v[188:191], v19 offset:4096
    ds_read_b128 v[196:199], v21
    ds_read_b64_tr_b16 v[152:153], v23 offset:0
    ds_read_b64_tr_b16 v[154:155], v23 offset:256
    ds_read_b64_tr_b16 v[156:157], v24 offset:0
    ds_read_b64_tr_b16 v[158:159], v24 offset:256
    ds_read_b64_tr_b16 v[160:161], v25 offset:0
    ds_read_b64_tr_b16 v[162:163], v25 offset:256
    ds_read_b64_tr_b16 v[164:165], v26 offset:0
    ds_read_b64_tr_b16 v[166:167], v26 offset:256
    ds_read_b64_tr_b16 v[168:169], v27 offset:0
    ds_read_b64_tr_b16 v[170:171], v27 offset:256
    ds_read_b64_tr_b16 v[172:173], v28 offset:0
    ds_read_b64_tr_b16 v[174:175], v28 offset:256
    ds_read_b64_tr_b16 v[176:177], v29 offset:0
    ds_read_b64_tr_b16 v[178:179], v29 offset:256
A1_CLOOP:
    s_waitcnt lgkmcnt(0)
    v_mfma_f32_16x16x32_bf16 v[32:35], v[152:155], v[180:183], v[32:35]
    ds_read_b128 v[228:231], v20 offset:0
    v_mfma_f32_16x16x32_bf16 v[60:63], v[152:155], v[184:187], v[60:63]
    ds_read_b128 v[232:235], v20 offset:2048
    v_mfma_f32_16x16x32_bf16 v[88:91], v[152:155], v[188:191], v[88:91]
    ds_read_b128 v[236:239], v20 offset:4096
    v_mfma_f32_16x16x32_bf16 v[116:119], v[152:155], v[196:199], v[116:119]
    ds_read_b128 v[244:247], v22
    v_mfma_f32_16x16x32_bf16 v[36:39], v[156:159], v[180:183], v[36:39]
    ds_read_b64_tr_b16 v[200:201], v23 offset:8192
    v_mfma_f32_16x16x32_bf16 v[64:67], v[156:159], v[184:187], v[64:67]
    ds_read_b64_tr_b16 v[202:203], v23 offset:8448
    v_mfma_f32_16x16x32_bf16 v[92:95], v[156:159], v[188:191], v[92:95]
    ds_read_b64_tr_b16 v[204:205], v24 offset:8192
    v_mfma_f32_16x16x32_bf16 v[120:123], v[156:159], v[196:199], v[120:123]
    ds_read_b64_tr_b16 v[206:207], v24 offset:8448
    v_mfma_f32_16x16x32_bf16 v[40:43], v[160:163], v[180:183], v[40:43]
    ds_read_b64_tr_b16 v[208:209], v25 offset:8192
    v_mfma_f32_16x16x32_bf16 v[68:71], v[160:163], v[184:187], v[68:71]
    ds_read_b64_tr_b16 v[210:211], v25 offset:8448
    v_mfma_f32_16x16x32_bf16 v[96:99], v[160:163], v[188:191], v[96:99]
    ds_read_b64_tr_b16 v[212:213], v26 offset:8192
    v_mfma_f32_16x16x32_bf16 v[44:47], v[164:167], v[180:183], v[44:47]
    ds_read_b64_tr_b16 v[214:215], v26 offset:8448
    v_mfma_f32_16x16x32_bf16 v[72:75], v[164:167], v[184:187], v[72:75]
    ds_read_b64_tr_b16 v[216:217], v27 offset:8192
    v_mfma_f32_16x16x32_bf16 v[100:103], v[164:167], v[188:191], v[100:103]
    ds_read_b64_tr_b16 v[218:219], v27 offset:8448
    v_mfma_f32_16x16x32_bf16 v[48:51], v[168:171], v[180:183], v[48:51]
    ds_read_b64_tr_b16 v[220:221], v28 offset:8192
    v_mfma_f32_16x16x32_bf16 v[76:79], v[168:171], v[184:187], v[76:79]
    ds_read_b64_tr_b16 v[222:223], v28 offset:8448
    v_mfma_f32_16x16x32_bf16 v[104:107], v[168:171], v[188:191], v[104:107]
    ds_read_b64_tr_b16 v[224:225], v29 offset:8192
    v_mfma_f32_16x16x32_bf16 v[52:55], v[172:175], v[180:183], v[52:55]
    ds_read_b64_tr_b16 v[226:227], v29 offset:8448
    v_mfma_f32_16x16x32_bf16 v[80:83], v[172:175], v[184:187], v[80:83]
    v_mfma_f32_16x16x32_bf16 v[108:111], v[172:175], v[188:191], v[108:111]
    v_mfma_f32_16x16x32_bf16 v[56:59], v[176:179], v[180:183], v[56:59]
    v_mfma_f32_16x16x32_bf16 v[84:87], v[176:179], v[184:187], v[84:87]
    v_mfma_f32_16x16x32_bf16 v[112:115], v[176:179], v[188:191], v[112:115]
    s_mov_b32 s11, s10
    s_add_u32 s10, s10, 43008
    s_cmp_eq_u32 s10, 129024
    s_cselect_b32 s10, 0, s10
    s_sub_i32 s9, s10, s11
    s_waitcnt lgkmcnt(0)
    v_add_u32 v19, s9, v19
    v_add_u32 v20, s9, v20
    v_add_u32 v21, s9, v21
    v_add_u32 v22, s9, v22
    v_add_u32 v23, s9, v23
    v_add_u32 v24, s9, v24
    v_add_u32 v25, s9, v25
    v_add_u32 v26, s9, v26
    v_add_u32 v27, s9, v27
    v_add_u32 v28, s9, v28
    v_add_u32 v29, s9, v29
    s_cmp_eq_u32 s7, 8
    s_cbranch_scc1 A1_CLAST
    s_barrier
    v_mfma_f32_16x16x32_bf16 v[32:35], v[200:203], v[228:231], v[32:35]
    ds_read_b128 v[180:183], v19 offset:0
    v_mfma_f32_16x16x32_bf16 v[60:63], v[200:203], v[232:235], v[60:63]
    ds_read_b128 v[184:187], v19 offset:2048
    v_mfma_f32_16x16x32_bf16 v[88:91], v[200:203], v[236:239], v[88:91]
    ds_read_b128 v[188:191], v19 offset:4096
    v_mfma_f32_16x16x32_bf16 v[116:119], v[200:203], v[244:247], v[116:119]
    ds_read_b128 v[196:199], v21
    v_mfma_f32_16x16x32_bf16 v[36:39], v[204:207], v[228:231], v[36:39]
    ds_read_b64_tr_b16 v[152:153], v23 offset:0
    v_mfma_f32_16x16x32_bf16 v[64:67], v[204:207], v[232:235], v[64:67]
    ds_read_b64_tr_b16 v[154:155], v23 offset:256
    v_mfma_f32_16x16x32_bf16 v[92:95], v[204:207], v[236:239], v[92:95]
    ds_read_b64_tr_b16 v[156:157], v24 offset:0
    v_mfma_f32_16x16x32_bf16 v[120:123], v[204:207], v[244:247], v[120:123]
    ds_read_b64_tr_b16 v[158:159], v24 offset:256
    v_mfma_f32_16x16x32_bf16 v[40:43], v[208:211], v[228:231], v[40:43]
    ds_read_b64_tr_b16 v[160:161], v25 offset:0
    v_mfma_f32_16x16x32_bf16 v[68:71], v[208:211], v[232:235], v[68:71]
    ds_read_b64_tr_b16 v[162:163], v25 offset:256
    v_mfma_f32_16x16x32_bf16 v[96:99], v[208:211], v[236:239], v[96:99]
    ds_read_b64_tr_b16 v[164:165], v26 offset:0
    v_mfma_f32_16x16x32_bf16 v[44:47], v[212:215], v[228:231], v[44:47]
    ds_read_b64_tr_b16 v[166:167], v26 offset:256
    v_mfma_f32_16x16x32_bf16 v[72:75], v[212:215], v[232:235], v[72:75]
    ds_read_b64_tr_b16 v[168:169], v27 offset:0
    v_mfma_f32_16x16x32_bf16 v[100:103], v[212:215], v[236:239], v[100:103]
    ds_read_b64_tr_b16 v[170:171], v27 offset:256
    v_mfma_f32_16x16x32_bf16 v[48:51], v[216:219], v[228:231], v[48:51]
    ds_read_b64_tr_b16 v[172:173], v28 offset:0
    v_mfma_f32_16x16x32_bf16 v[76:79], v[216:219], v[232:235], v[76:79]
    ds_read_b64_tr_b16 v[174:175], v28 offset:256
    v_mfma_f32_16x16x32_bf16 v[104:107], v[216:219], v[236:239], v[104:107]
    ds_read_b64_tr_b16 v[176:177], v29 offset:0
    v_mfma_f32_16x16x32_bf16 v[52:55], v[220:223], v[228:231], v[52:55]
    ds_read_b64_tr_b16 v[178:179], v29 offset:256
    v_mfma_f32_16x16x32_bf16 v[80:83], v[220:223], v[232:235], v[80:83]
    v_mfma_f32_16x16x32_bf16 v[108:111], v[220:223], v[236:239], v[108:111]
    v_mfma_f32_16x16x32_bf16 v[56:59], v[224:227], v[228:231], v[56:59]
    v_mfma_f32_16x16x32_bf16 v[84:87], v[224:227], v[232:235], v[84:87]
    v_mfma_f32_16x16x32_bf16 v[112:115], v[224:227], v[236:239], v[112:115]
    s_add_i32 s7, s7, 1
    s_branch A1_CLOOP
A1_CLAST:
    s_mul_i32 s8, s6, 48
    s_add_u32 s8, s8, 16
    s_mul_i32 s8, s8, 272
    v_mfma_f32_16x16x32_bf16 v[116:119], v[200:203], v[244:247], v[116:119]
    v_mfma_f32_16x16x32_bf16 v[32:35], v[200:203], v[228:231], v[32:35]
    v_mfma_f32_16x16x32_bf16 v[60:63], v[200:203], v[232:235], v[60:63]
    v_mfma_f32_16x16x32_bf16 v[88:91], v[200:203], v[236:239], v[88:91]
    v_mfma_f32_16x16x32_bf16 v[120:123], v[204:207], v[244:247], v[120:123]
    v_mfma_f32_16x16x32_bf16 v[36:39], v[204:207], v[228:231], v[36:39]
    v_mfma_f32_16x16x32_bf16 v[64:67], v[204:207], v[232:235], v[64:67]
    v_mfma_f32_16x16x32_bf16 v[92:95], v[204:207], v[236:239], v[92:95]
    v_mfma_f32_16x16x32_bf16 v[40:43], v[208:211], v[228:231], v[40:43]
    v_mfma_f32_16x16x32_bf16 v[68:71], v[208:211], v[232:235], v[68:71]
    v_mfma_f32_16x16x32_bf16 v[96:99], v[208:211], v[236:239], v[96:99]
    v_mfma_f32_16x16x32_bf16 v[44:47], v[212:215], v[228:231], v[44:47]
    v_cvt_pk_bf16_f32 v152, v116, v117
    v_cvt_pk_bf16_f32 v153, v118, v119
    ds_write_b64 v8, v[152:153] offset:0
    v_add_u32 v8, s8, v8
    v_cvt_pk_bf16_f32 v154, v32, v33
    v_mfma_f32_16x16x32_bf16 v[72:75], v[212:215], v[232:235], v[72:75]
    v_cvt_pk_bf16_f32 v155, v34, v35
    ds_write_b64 v8, v[154:155] offset:0
    v_cvt_pk_bf16_f32 v156, v60, v61
    v_cvt_pk_bf16_f32 v157, v62, v63
    ds_write_b64 v8, v[156:157] offset:4352
    v_mfma_f32_16x16x32_bf16 v[100:103], v[212:215], v[236:239], v[100:103]
    v_cvt_pk_bf16_f32 v158, v88, v89
    v_cvt_pk_bf16_f32 v159, v90, v91
    ds_write_b64 v8, v[158:159] offset:8704
    v_mfma_f32_16x16x32_bf16 v[48:51], v[216:219], v[228:231], v[48:51]
    v_cvt_pk_bf16_f32 v160, v120, v121
    v_cvt_pk_bf16_f32 v161, v122, v123
    ds_write_b64 v9, v[160:161] offset:0
    v_add_u32 v9, s8, v9
    v_cvt_pk_bf16_f32 v162, v36, v37
    v_mfma_f32_16x16x32_bf16 v[76:79], v[216:219], v[232:235], v[76:79]
    v_cvt_pk_bf16_f32 v163, v38, v39
    ds_write_b64 v9, v[162:163] offset:0
    v_cvt_pk_bf16_f32 v164, v64, v65
    v_cvt_pk_bf16_f32 v165, v66, v67
    ds_write_b64 v9, v[164:165] offset:4352
    v_mfma_f32_16x16x32_bf16 v[104:107], v[216:219], v[236:239], v[104:107]
    v_cvt_pk_bf16_f32 v166, v92, v93
    v_cvt_pk_bf16_f32 v167, v94, v95
    ds_write_b64 v9, v[166:167] offset:8704
    v_mfma_f32_16x16x32_bf16 v[52:55], v[220:223], v[228:231], v[52:55]
    v_add_u32 v10, s8, v10
    v_cvt_pk_bf16_f32 v168, v40, v41
    v_cvt_pk_bf16_f32 v169, v42, v43
    ds_write_b64 v10, v[168:169] offset:0
    v_mfma_f32_16x16x32_bf16 v[80:83], v[220:223], v[232:235], v[80:83]
    v_cvt_pk_bf16_f32 v170, v68, v69
    v_cvt_pk_bf16_f32 v171, v70, v71
    ds_write_b64 v10, v[170:171] offset:4352
    v_cvt_pk_bf16_f32 v172, v96, v97
    v_mfma_f32_16x16x32_bf16 v[108:111], v[220:223], v[236:239], v[108:111]
    v_cvt_pk_bf16_f32 v173, v98, v99
    ds_write_b64 v10, v[172:173] offset:8704
    v_mfma_f32_16x16x32_bf16 v[56:59], v[224:227], v[228:231], v[56:59]
    v_add_u32 v11, s8, v11
    v_cvt_pk_bf16_f32 v174, v44, v45
    v_cvt_pk_bf16_f32 v175, v46, v47
    ds_write_b64 v11, v[174:175] offset:0
    v_mfma_f32_16x16x32_bf16 v[84:87], v[224:227], v[232:235], v[84:87]
    v_cvt_pk_bf16_f32 v176, v72, v73
    v_cvt_pk_bf16_f32 v177, v74, v75
    ds_write_b64 v11, v[176:177] offset:4352
    v_cvt_pk_bf16_f32 v178, v100, v101
    v_mfma_f32_16x16x32_bf16 v[112:115], v[224:227], v[236:239], v[112:115]
    v_cvt_pk_bf16_f32 v179, v102, v103
    ds_write_b64 v11, v[178:179] offset:8704
    v_add_u32 v12, s8, v12
    v_cvt_pk_bf16_f32 v180, v48, v49
    v_cvt_pk_bf16_f32 v181, v50, v51
    ds_write_b64 v12, v[180:181] offset:0
    v_cvt_pk_bf16_f32 v182, v76, v77
    v_cvt_pk_bf16_f32 v183, v78, v79
    ds_write_b64 v12, v[182:183] offset:4352
    v_cvt_pk_bf16_f32 v152, v104, v105
    v_cvt_pk_bf16_f32 v153, v106, v107
    ds_write_b64 v12, v[152:153] offset:8704
    v_add_u32 v13, s8, v13
    v_cvt_pk_bf16_f32 v154, v52, v53
    v_cvt_pk_bf16_f32 v155, v54, v55
    ds_write_b64 v13, v[154:155] offset:0
    v_cvt_pk_bf16_f32 v156, v80, v81
    v_cvt_pk_bf16_f32 v157, v82, v83
    ds_write_b64 v13, v[156:157] offset:4352
    v_cvt_pk_bf16_f32 v158, v108, v109
    v_cvt_pk_bf16_f32 v159, v110, v111
    ds_write_b64 v13, v[158:159] offset:8704
    v_add_u32 v14, s8, v14
    v_cvt_pk_bf16_f32 v160, v56, v57
    v_cvt_pk_bf16_f32 v161, v58, v59
    ds_write_b64 v14, v[160:161] offset:0
    v_cvt_pk_bf16_f32 v162, v84, v85
    v_cvt_pk_bf16_f32 v163, v86, v87
    ds_write_b64 v14, v[162:163] offset:4352
    v_cvt_pk_bf16_f32 v164, v112, v113
    v_cvt_pk_bf16_f32 v165, v114, v115
    ds_write_b64 v14, v[164:165] offset:8704
A1_JOIN:
    v_lshrrev_b32 v1, 6, v0
    v_and_b32 v3, 31, v0
    v_lshl_add_u32 v1, v1, 5, v3
    v_bfe_u32 v8, v0, 5, 1
    v_add_u32 v3, 2, v1
    v_mul_u32_u24 v3, 272, v3
    v_mul_u32_u24 v4, 48, v8
    v_add_u32 v4, v3, v4
    v_lshl_add_u32 v3, v8, 2, v3
    v_mov_b32 v100, 0
    v_mov_b32 v101, 0
    v_mov_b32 v102, 0
    v_mov_b32 v103, 0
    v_mov_b32 v104, 0
    v_mov_b32 v105, 0
    v_mov_b32 v106, 0
    v_mov_b32 v107, 0
    s_waitcnt lgkmcnt(0)
    s_barrier
    s_cmp_ge_u32 s6, 6
    s_cbranch_scc1 A1_NOATT
    ds_read_b128 v[10:13], v4 offset:3968
    ds_read_b128 v[14:17], v4 offset:3984
    ds_read_b32 v18, v3 offset:4000
    ds_read_b128 v[20:23], v4 offset:3808
    ds_read_b128 v[24:27], v4 offset:3824
    ds_read_b32 v28, v3 offset:3840
    ds_read_b128 v[30:33], v4 offset:3264
    ds_read_b128 v[34:37], v4 offset:3280
    ds_read_b32 v38, v3 offset:3296
    ds_read_b128 v[40:43], v4 offset:2720
    ds_read_b128 v[44:47], v4 offset:2736
    ds_read_b32 v48, v3 offset:2752
    ds_read_b128 v[50:53], v4 offset:2176
    ds_read_b128 v[54:57], v4 offset:2192
    ds_read_b32 v58, v3 offset:2208
    s_waitcnt lgkmcnt(0)
    ds_read_b128 v[60:63], v4 offset:1632
    ds_read_b128 v[64:67], v4 offset:1648
    ds_read_b32 v68, v3 offset:1664
    ds_read_b128 v[70:73], v4 offset:1088
    ds_read_b128 v[74:77], v4 offset:1104
    ds_read_b32 v78, v3 offset:1120
    ds_read_b128 v[80:83], v4 offset:544
    ds_read_b128 v[84:87], v4 offset:560
    ds_read_b32 v88, v3 offset:576
    ds_read_b128 v[90:93], v4 offset:0
    ds_read_b128 v[94:97], v4 offset:16
    ds_read_b32 v98, v3 offset:32
    v_dot2c_f32_bf16 v100, v10, v20
    v_dot2c_f32_bf16 v101, v10, v30
    v_dot2c_f32_bf16 v102, v10, v40
    v_dot2c_f32_bf16 v103, v10, v50
    v_dot2c_f32_bf16 v100, v11, v21
    v_dot2c_f32_bf16 v101, v11, v31
    v_dot2c_f32_bf16 v102, v11, v41
    v_dot2c_f32_bf16 v103, v11, v51
    v_dot2c_f32_bf16 v100, v12, v22
    v_dot2c_f32_bf16 v101, v12, v32
    v_dot2c_f32_bf16 v102, v12, v42
    v_dot2c_f32_bf16 v103, v12, v52
    v_dot2c_f32_bf16 v100, v13, v23
    v_dot2c_f32_bf16 v101, v13, v33
    v_dot2c_f32_bf16 v102, v13, v43
    v_dot2c_f32_bf16 v103, v13, v53
    v_dot2c_f32_bf16 v100, v14, v24
    v_dot2c_f32_bf16 v101, v14, v34
    v_dot2c_f32_bf16 v102, v14, v44
    v_dot2c_f32_bf16 v103, v14, v54
    v_dot2c_f32_bf16 v100, v15, v25
    v_dot2c_f32_bf16 v101, v15, v35
    v_dot2c_f32_bf16 v102, v15, v45
    v_dot2c_f32_bf16 v103, v15, v55
    v_dot2c_f32_bf16 v100, v16, v26
    v_dot2c_f32_bf16 v101, v16, v36
    v_dot2c_f32_bf16 v102, v16, v46
    v_dot2c_f32_bf16 v103, v16, v56
    v_dot2c_f32_bf16 v100, v17, v27
    v_dot2c_f32_bf16 v101, v17, v37
    v_dot2c_f32_bf16 v102, v17, v47
    v_dot2c_f32_bf16 v103, v17, v57
    v_dot2c_f32_bf16 v100, v18, v28
    v_dot2c_f32_bf16 v101, v18, v38
    v_dot2c_f32_bf16 v102, v18, v48
    v_dot2c_f32_bf16 v103, v18, v58
    s_waitcnt lgkmcnt(0)
    ds_read_b128 v[120:123], v4 offset:3888
    ds_read_b128 v[124:127], v4 offset:3904
    ds_read_b32 v128, v3 offset:3920
    ds_read_b128 v[130:133], v4 offset:3344
    ds_read_b128 v[134:137], v4 offset:3360
    ds_read_b32 v138, v3 offset:3376
    ds_read_b128 v[140:143], v4 offset:2800
    ds_read_b128 v[144:147], v4 offset:2816
    ds_read_b32 v148, v3 offset:2832
    ds_read_b128 v[150:153], v4 offset:2256
    ds_read_b128 v[154:157], v4 offset:2272
    ds_read_b32 v158, v3 offset:2288
    v_dot2c_f32_bf16 v104, v10, v60
    v_dot2c_f32_bf16 v105, v10, v70
    v_dot2c_f32_bf16 v106, v10, v80
    v_dot2c_f32_bf16 v107, v10, v90
    v_dot2c_f32_bf16 v104, v11, v61
    v_dot2c_f32_bf16 v105, v11, v71
    v_dot2c_f32_bf16 v106, v11, v81
    v_dot2c_f32_bf16 v107, v11, v91
    v_dot2c_f32_bf16 v104, v12, v62
    v_dot2c_f32_bf16 v105, v12, v72
    v_dot2c_f32_bf16 v106, v12, v82
    v_dot2c_f32_bf16 v107, v12, v92
    v_dot2c_f32_bf16 v104, v13, v63
    v_dot2c_f32_bf16 v105, v13, v73
    v_dot2c_f32_bf16 v106, v13, v83
    v_dot2c_f32_bf16 v107, v13, v93
    v_dot2c_f32_bf16 v104, v14, v64
    v_dot2c_f32_bf16 v105, v14, v74
    v_dot2c_f32_bf16 v106, v14, v84
    v_dot2c_f32_bf16 v107, v14, v94
    v_dot2c_f32_bf16 v104, v15, v65
    v_dot2c_f32_bf16 v105, v15, v75
    v_dot2c_f32_bf16 v106, v15, v85
    v_dot2c_f32_bf16 v107, v15, v95
    v_dot2c_f32_bf16 v104, v16, v66
    v_dot2c_f32_bf16 v105, v16, v76
    v_dot2c_f32_bf16 v106, v16, v86
    v_dot2c_f32_bf16 v107, v16, v96
    v_dot2c_f32_bf16 v104, v17, v67
    v_dot2c_f32_bf16 v105, v17, v77
    v_dot2c_f32_bf16 v106, v17, v87
    v_dot2c_f32_bf16 v107, v17, v97
    v_dot2c_f32_bf16 v104, v18, v68
    v_dot2c_f32_bf16 v105, v18, v78
    v_dot2c_f32_bf16 v106, v18, v88
    v_dot2c_f32_bf16 v107, v18, v98
    ds_read_b128 v[160:163], v4 offset:1712
    ds_read_b128 v[164:167], v4 offset:1728
    ds_read_b32 v168, v3 offset:1744
    ds_read_b128 v[170:173], v4 offset:1168
    ds_read_b128 v[174:177], v4 offset:1184
    ds_read_b32 v178, v3 offset:1200
    ds_read_b128 v[180:183], v4 offset:624
    ds_read_b128 v[184:187], v4 offset:640
    ds_read_b32 v188, v3 offset:656
    ds_read_b128 v[190:193], v4 offset:80
    ds_read_b128 v[194:197], v4 offset:96
    ds_read_b32 v198, v3 offset:112
    s_cmp_lg_u32 s4, 0
    s_cbranch_scc1 Lnomask_2
    v_mov_b32 v110, 0xf149f2ca
    v_cmp_gt_u32 vcc, 2, v1
    s_nop 1
    v_cndmask_b32 v101, v101, v110, vcc
    v_cmp_gt_u32 vcc, 4, v1
    s_nop 1
    v_cndmask_b32 v102, v102, v110, vcc
    v_cmp_gt_u32 vcc, 6, v1
    s_nop 1
    v_cndmask_b32 v103, v103, v110, vcc
    v_cmp_gt_u32 vcc, 8, v1
    s_nop 1
    v_cndmask_b32 v104, v104, v110, vcc
    v_cmp_gt_u32 vcc, 10, v1
    s_nop 1
    v_cndmask_b32 v105, v105, v110, vcc
    v_cmp_gt_u32 vcc, 12, v1
    s_nop 1
    v_cndmask_b32 v106, v106, v110, vcc
    v_cmp_gt_u32 vcc, 14, v1
    s_nop 1
    v_cndmask_b32 v107, v107, v110, vcc
Lnomask_2:
    v_max3_f32 v110, v100, v101, v102
    v_max3_f32 v111, v103, v104, v105
    v_max3_f32 v110, v110, v106, v107
    s_mov_b32 s8, 0x3eae1a93
    v_max_f32 v110, v110, v111
    v_mul_f32 v111, s8, v110
    v_fma_f32 v100, v100, s8, -v111
    v_fma_f32 v101, v101, s8, -v111
    v_fma_f32 v102, v102, s8, -v111
    v_fma_f32 v103, v103, s8, -v111
    v_fma_f32 v104, v104, s8, -v111
    v_fma_f32 v105, v105, s8, -v111
    v_fma_f32 v106, v106, s8, -v111
    v_fma_f32 v107, v107, s8, -v111
    v_exp_f32 v100, v100
    v_exp_f32 v101, v101
    v_exp_f32 v102, v102
    v_exp_f32 v103, v103
    v_exp_f32 v104, v104
    v_exp_f32 v105, v105
    v_exp_f32 v106, v106
    v_exp_f32 v107, v107
    v_add_f32 v110, v100, v101
    v_add_f32 v111, v102, v103
    v_add_f32 v112, v104, v105
    v_add_f32 v113, v106, v107
    v_add_f32 v110, v110, v111
    v_add_f32 v112, v112, v113
    v_add_f32 v110, v110, v112
    v_rcp_f32 v110, v110
    s_mov_b32 s8, 0x05040100
    s_mov_b32 s9, 0x07060302
    v_mul_f32 v100, v100, v110
    v_mul_f32 v101, v101, v110
    v_mul_f32 v102, v102, v110
    v_mul_f32 v103, v103, v110
    v_mul_f32 v104, v104, v110
    v_mul_f32 v105, v105, v110
    v_mul_f32 v106, v106, v110
    v_mul_f32 v107, v107, v110
    v_cvt_pk_bf16_f32 v112, v100, v101
    v_cvt_pk_bf16_f32 v113, v102, v103
    v_cvt_pk_bf16_f32 v114, v104, v105
    v_cvt_pk_bf16_f32 v115, v106, v107
    s_waitcnt lgkmcnt(0)
    s_barrier
    s_and_b32 s11, s2, 7
    s_lshr_b32 s12, s2, 3
    s_cmp_ge_u32 s12, 9
    s_cselect_b32 s8, 1, 0
    s_cselect_b32 s9, 9, 0
    s_sub_u32 s15, s12, s9
    s_lshl_b32 s14, s11, 1
    s_add_u32 s14, s14, s8
    s_mov_b32 s8, 0x05040100
    s_mov_b32 s9, 0x07060302
    v_perm_b32 v40, v130, v120, s8
    v_perm_b32 v41, v130, v120, s9
    v_perm_b32 v42, v131, v121, s8
    v_perm_b32 v43, v131, v121, s9
    v_perm_b32 v44, v132, v122, s8
    v_perm_b32 v45, v132, v122, s9
    v_perm_b32 v46, v133, v123, s8
    v_perm_b32 v47, v133, v123, s9
    v_perm_b32 v48, v134, v124, s8
    v_perm_b32 v49, v134, v124, s9
    v_perm_b32 v50, v135, v125, s8
    v_perm_b32 v51, v135, v125, s9
    v_perm_b32 v52, v136, v126, s8
    v_perm_b32 v53, v136, v126, s9
    v_perm_b32 v54, v137, v127, s8
    v_perm_b32 v55, v137, v127, s9
    v_perm_b32 v56, v138, v128, s8
    v_perm_b32 v57, v138, v128, s9
    v_dot2_f32_bf16 v20, v40, v112, 0
    v_dot2_f32_bf16 v21, v41, v112, 0
    v_dot2_f32_bf16 v22, v42, v112, 0
    v_dot2_f32_bf16 v23, v43, v112, 0
    v_dot2_f32_bf16 v24, v44, v112, 0
    v_dot2_f32_bf16 v25, v45, v112, 0
    v_dot2_f32_bf16 v26, v46, v112, 0
    v_dot2_f32_bf16 v27, v47, v112, 0
    v_dot2_f32_bf16 v28, v48, v112, 0
    v_dot2_f32_bf16 v29, v49, v112, 0
    v_dot2_f32_bf16 v30, v50, v112, 0
    v_dot2_f32_bf16 v31, v51, v112, 0
    v_dot2_f32_bf16 v32, v52, v112, 0
    v_dot2_f32_bf16 v33, v53, v112, 0
    v_dot2_f32_bf16 v34, v54, v112, 0
    v_dot2_f32_bf16 v35, v55, v112, 0
    v_dot2_f32_bf16 v36, v56, v112, 0
    v_dot2_f32_bf16 v37, v57, v112, 0
    v_perm_b32 v40, v150, v140, s8
    v_perm_b32 v41, v150, v140, s9
    v_perm_b32 v42, v151, v141, s8
    v_perm_b32 v43, v151, v141, s9
    v_perm_b32 v44, v152, v142, s8
    v_perm_b32 v45, v152, v142, s9
    v_perm_b32 v46, v153, v143, s8
    v_perm_b32 v47, v153, v143, s9
    v_perm_b32 v48, v154, v144, s8
    v_perm_b32 v49, v154, v144, s9
    v_perm_b32 v50, v155, v145, s8
    v_perm_b32 v51, v155, v145, s9
    v_perm_b32 v52, v156, v146, s8
    v_perm_b32 v53, v156, v146, s9
    v_perm_b32 v54, v157, v147, s8
    v_perm_b32 v55, v157, v147, s9
    v_perm_b32 v56, v158, v148, s8
    v_perm_b32 v57, v158, v148, s9
    v_dot2c_f32_bf16 v20, v40, v113
    v_dot2c_f32_bf16 v21, v41, v113
    v_dot2c_f32_bf16 v22, v42, v113
    v_dot2c_f32_bf16 v23, v43, v113
    v_dot2c_f32_bf16 v24, v44, v113
    v_dot2c_f32_bf16 v25, v45, v113
    v_dot2c_f32_bf16 v26, v46, v113
    v_dot2c_f32_bf16 v27, v47, v113
    v_dot2c_f32_bf16 v28, v48, v113
    v_dot2c_f32_bf16 v29, v49, v113
    v_dot2c_f32_bf16 v30, v50, v113
    v_dot2c_f32_bf16 v31, v51, v113
    v_dot2c_f32_bf16 v32, v52, v113
    v_dot2c_f32_bf16 v33, v53, v113
    v_dot2c_f32_bf16 v34, v54, v113
    v_dot2c_f32_bf16 v35, v55, v113
    v_dot2c_f32_bf16 v36, v56, v113
    v_dot2c_f32_bf16 v37, v57, v113
    v_perm_b32 v40, v170, v160, s8
    v_perm_b32 v41, v170, v160, s9
    v_perm_b32 v42, v171, v161, s8
    v_perm_b32 v43, v171, v161, s9
    v_perm_b32 v44, v172, v162, s8
    v_perm_b32 v45, v172, v162, s9
    v_perm_b32 v46, v173, v163, s8
    v_perm_b32 v47, v173, v163, s9
    v_perm_b32 v48, v174, v164, s8
    v_perm_b32 v49, v174, v164, s9
    v_perm_b32 v50, v175, v165, s8
    v_perm_b32 v51, v175, v165, s9
    v_perm_b32 v52, v176, v166, s8
    v_perm_b32 v53, v176, v166, s9
    v_perm_b32 v54, v177, v167, s8
    v_perm_b32 v55, v177, v167, s9
    v_perm_b32 v56, v178, v168, s8
    v_perm_b32 v57, v178, v168, s9
    v_dot2c_f32_bf16 v20, v40, v114
    v_dot2c_f32_bf16 v21, v41, v114
    v_dot2c_f32_bf16 v22, v42, v114
    v_dot2c_f32_bf16 v23, v43, v114
    v_dot2c_f32_bf16 v24, v44, v114
    v_dot2c_f32_bf16 v25, v45, v114
    v_dot2c_f32_bf16 v26, v46, v114
    v_dot2c_f32_bf16 v27, v47, v114
    v_dot2c_f32_bf16 v28, v48, v114
    v_dot2c_f32_bf16 v29, v49, v114
    v_dot2c_f32_bf16 v30, v50, v114
    v_dot2c_f32_bf16 v31, v51, v114
    v_dot2c_f32_bf16 v32, v52, v114
    v_dot2c_f32_bf16 v33, v53, v114
    v_dot2c_f32_bf16 v34, v54, v114
    v_dot2c_f32_bf16 v35, v55, v114
    v_dot2c_f32_bf16 v36, v56, v114
    v_dot2c_f32_bf16 v37, v57, v114
    v_perm_b32 v40, v190, v180, s8
    v_perm_b32 v41, v190, v180, s9
    v_perm_b32 v42, v191, v181, s8
    v_perm_b32 v43, v191, v181, s9
    v_perm_b32 v44, v192, v182, s8
    v_perm_b32 v45, v192, v182, s9
    v_perm_b32 v46, v193, v183, s8
    v_perm_b32 v47, v193, v183, s9
    v_perm_b32 v48, v194, v184, s8
    v_perm_b32 v49, v194, v184, s9
    v_perm_b32 v50, v195, v185, s8
    v_perm_b32 v51, v195, v185, s9
    v_perm_b32 v52, v196, v186, s8
    v_perm_b32 v53, v196, v186, s9
    v_perm_b32 v54, v197, v187, s8
    v_perm_b32 v55, v197, v187, s9
    v_perm_b32 v56, v198, v188, s8
    v_perm_b32 v57, v198, v188, s9
    v_dot2c_f32_bf16 v20, v40, v115
    v_dot2c_f32_bf16 v21, v41, v115
    v_dot2c_f32_bf16 v22, v42, v115
    v_dot2c_f32_bf16 v23, v43, v115
    v_dot2c_f32_bf16 v24, v44, v115
    v_dot2c_f32_bf16 v25, v45, v115
    v_dot2c_f32_bf16 v26, v46, v115
    v_dot2c_f32_bf16 v27, v47, v115
    v_dot2c_f32_bf16 v28, v48, v115
    v_dot2c_f32_bf16 v29, v49, v115
    v_dot2c_f32_bf16 v30, v50, v115
    v_dot2c_f32_bf16 v31, v51, v115
    v_dot2c_f32_bf16 v32, v52, v115
    v_dot2c_f32_bf16 v33, v53, v115
    v_dot2c_f32_bf16 v34, v54, v115
    v_dot2c_f32_bf16 v35, v55, v115
    v_dot2c_f32_bf16 v36, v56, v115
    v_dot2c_f32_bf16 v37, v57, v115
    s_add_u32 s48, s38, 0
    s_addc_u32 s49, s39, 0
    s_and_b32 s49, s49, 0xffff
    s_mov_b32 s50, 2621440
    s_mov_b32 s51, 0x00020000
    s_lshr_b32 s8, s5, 2
    s_mul_i32 s8, s8, 5120
    s_and_b32 s9, s5, 3
    s_lshl_b32 s9, s9, 8
    s_add_u32 s8, s8, s9
    s_mul_i32 s12, s4, 245760
    s_add_u32 s12, s12, s8
    v_lshrrev_b32 v4, 4, v1
    v_mul_u32_u24 v4, 20480, v4
    v_and_b32 v5, 15, v1
    v_lshl_add_u32 v4, v5, 4, v4
    v_add_u32 v4, s12, v4
    v_lshlrev_b32 v5, 11, v8
    v_add_u32 v5, v4, v5
    v_cvt_pk_bf16_f32 v60, v20, v21
    v_cvt_pk_bf16_f32 v61, v22, v23
    v_cvt_pk_bf16_f32 v62, v24, v25
    v_cvt_pk_bf16_f32 v63, v26, v27
    v_cvt_pk_bf16_f32 v64, v28, v29
    v_cvt_pk_bf16_f32 v65, v30, v31
    v_cvt_pk_bf16_f32 v66, v32, v33
    v_cvt_pk_bf16_f32 v67, v34, v35
    v_cvt_pk_bf16_f32 v68, v36, v37
    v_mov_b32 v69, 0
    v_mov_b32 v70, 0
    v_mov_b32 v71, 0
    buffer_store_dwordx4 v[60:63], v5, s[48:51], 0 offen sc1
    v_permlane32_swap_b32 v68, v69
    buffer_store_dwordx4 v[64:67], v5, s[48:51], 0 offen offset:1024 sc1
    s_mov_b32 s8, 4096
    s_mov_b64 exec, 0xffffffff
    buffer_store_dwordx4 v[68:71], v4, s[48:51], s8 offen sc1
    s_mov_b64 exec, -1
    s_branch A1_END
A1_NOATT:
    s_barrier
    s_and_b32 s11, s2, 7
    s_lshr_b32 s12, s2, 3
    s_cmp_ge_u32 s12, 9
    s_cselect_b32 s8, 1, 0
    s_cselect_b32 s9, 9, 0
    s_sub_u32 s15, s12, s9
    s_lshl_b32 s14, s11, 1
    s_add_u32 s14, s14, s8
    s_cmp_ge_u32 s2, 144
    s_cbranch_scc1 Lnopf_4
    v_lshrrev_b32 v3, 3, v2
    v_and_b32 v4, 7, v2
    v_bfe_u32 v5, v2, 4, 2
    v_lshlrev_b32 v5, 1, v5
    v_xor_b32 v4, v4, v5
    s_sub_u32 s7, s6, 6
    s_lshl_b32 s8, s7, 3
    v_add_u32 v3, s8, v3
    v_mul_u32_u24 v3, 1152, v3
    v_lshl_add_u32 v3, v4, 4, v3
    s_lshl_b32 s8, s15, 7
    v_add_u32 v3, s8, v3
    s_mov_b32 s44, s20
    s_and_b32 s45, s21, 0xffff
    s_mov_b32 s46, 663552
    s_mov_b32 s47, 0x00020000
    s_lshl_b32 s9, s7, 10
    s_mov_b32 s10, 0
Lwo_5:
    s_mov_b32 m0, s9
    s_add_u32 s9, s9, 2048
    buffer_load_dwordx4 v3, s[44:47], s10 offen lds
    s_add_u32 s10, s10, 18432
    s_cmp_lt_u32 s10, 663552
    s_cbranch_scc1 Lwo_5
Lnopf_4:
A1_END:
    s_lshl_b32 s69, s4, 7
    s_lshl_b32 s8, s5, 3
    s_add_u32 s69, s69, s8
    s_mov_b32 s4, s14
    s_mov_b32 s5, s15
    v_lshrrev_b32 v12, 4, v2
    v_bfe_u32 v13, v2, 2, 2
    v_and_b32 v14, 3, v2
    v_mul_u32_u24 v15, 36, v12
    v_add_u32 v15, v15, v13
    v_lshlrev_b32 v15, 7, v15
    v_and_b32 v16, 1, v14
    v_lshl_add_u32 v15, v16, 3, v15
    v_lshrrev_b32 v16, 1, v14
    v_lshrrev_b32 v17, 1, v13
    v_lshl_or_b32 v16, v17, 1, v16
    v_and_b32 v17, 1, v12
    v_lshl_or_b32 v16, v17, 2, v16
    v_xor_b32 v17, 0, v16
    v_lshl_add_u32 v8, v17, 4, v15
    v_xor_b32 v17, 2, v16
    v_lshl_add_u32 v9, v17, 4, v15
    v_xor_b32 v17, 4, v16
    v_lshl_add_u32 v10, v17, 4, v15
    v_xor_b32 v17, 6, v16
    v_lshl_add_u32 v11, v17, 4, v15
    v_and_b32 v3, 15, v2
    s_lshl_b32 s8, s4, 7
    s_lshl_b32 s9, s6, 4
    s_add_u32 s8, s8, s9
    v_add_u32 v3, s8, v3
    v_mul_u32_u24 v3, 2304, v3
    v_lshrrev_b32 v4, 4, v2
    v_lshl_add_u32 v3, v4, 3, v3
    s_lshl_b32 s8, s5, 7
    v_add_u32 v3, s8, v3
    s_cmp_ge_u32 s6, 6
    s_cbranch_scc1 F_NOW8
    s_mov_b32 s56, s36
    s_and_b32 s57, s37, 0xffff
    s_mov_b32 s58, 256
    s_mov_b32 s59, 0x00020000
    v_mov_b32 v252, 248
    buffer_load_dwordx2 v[250:251], v252, s[56:59], 0 offen sc1
    s_waitcnt vmcnt(0)
F_NOW8:
    s_add_u32 s52, s38, 10485760
    s_addc_u32 s53, s39, 0
    s_and_b32 s53, s53, 0xffff
    s_mov_b32 s54, 8192
    s_mov_b32 s55, 0x00020000
    s_barrier
    s_cmp_lg_u32 s6, 0
    s_cbranch_scc1 F_AW
    v_readfirstlane_b32 s66, v250
    v_readfirstlane_b32 s67, v251
    s_nop 3
    s_cmp_lg_u32 s66, 0
    s_cbranch_scc1 Ltagok_6
    s_mov_b32 s56, s36
    s_and_b32 s57, s37, 0xffff
    s_mov_b32 s58, 256
    s_mov_b32 s59, 0x00020000
    v_mov_b32 v252, 248
    s_mov_b32 s68, 0
Ltagpoll_7:
    buffer_load_dwordx2 v[250:251], v252, s[56:59], 0 offen sc1
    s_waitcnt vmcnt(0)
    v_readfirstlane_b32 s66, v250
    v_readfirstlane_b32 s67, v251
    s_add_u32 s68, s68, 1
    s_cmp_lg_u32 s66, 0
    s_cbranch_scc1 Ltagdone_8
    s_cmp_ge_u32 s68, 0x20000
    s_cbranch_scc1 Ltagdone_8
    s_sleep 1
    s_branch Ltagpoll_7
Ltagdone_8:
Ltagok_6:
    v_mov_b32 v250, s66
    v_mov_b32 v251, s67
    v_mov_b32 v252, s69
    s_mov_b64 s[62:63], exec
    s_mov_b64 exec, 1
    buffer_store_dwordx2 v[250:251], v252, s[52:55], 0 offen sc1
    s_mov_b64 exec, s[62:63]
    s_cmp_ge_u32 s2, 144
    s_cbranch_scc1 F_AW
    s_lshl_b32 s8, s4, 1
    s_mul_i32 s9, s8, 171
    s_lshr_b32 s9, s9, 9
    s_lshl_b32 s69, s9, 7
    s_mul_i32 s8, s4, 171
    s_lshr_b32 s8, s8, 9
    s_mul_i32 s8, s8, 3
    s_sub_u32 s8, s4, s8
    s_cmp_eq_u32 s8, 1
    s_cselect_b32 s61, -1, 0xffff
F_AW:
    s_cmp_ge_u32 s2, 144
    s_cbranch_scc1 F_EXIT
    s_add_u32 s48, s38, 0
    s_addc_u32 s49, s39, 0
    s_and_b32 s49, s49, 0xffff
    s_mov_b32 s50, 2621440
    s_mov_b32 s51, 0x00020000
    s_lshl_b32 s8, s4, 3
    s_add_u32 s8, s8, s6
    s_mul_i32 s8, s8, 20480
    v_lshlrev_b32 v6, 4, v2
    v_add_u32 v6, s8, v6
    s_mov_b32 s40, s34
    s_and_b32 s41, s35, 0xffff
    s_mov_b32 s42, 4718592
    s_mov_b32 s43, 0x00020000
    s_mov_b32 s59, 0
    s_cmp_lg_u32 s6, 0
    s_cbranch_scc1 La2w_9
    s_and_b32 s60, s61, 0xf000f
    s_and_b32 s64, s59, s60
    s_cmp_eq_u32 s64, s60
    s_cbranch_scc1 Lfskip_12
    s_mov_b64 s[62:63], exec
    s_mov_b64 exec, 0xffffffff
    v_lshlrev_b32 v252, 3, v0
    v_add_u32 v252, s69, v252
    s_mov_b32 s68, 0
    buffer_load_dwordx2 v[250:251], v252, s[52:55], 0 offen sc1
Lfpoll_10:
    s_sleep 2
    buffer_load_dwordx2 v[254:255], v252, s[52:55], 0 offen sc1
    s_waitcnt vmcnt(1)
    v_cmp_eq_u32 vcc, s66, v250
    v_cmp_eq_u32 s[64:65], s67, v251
    s_add_u32 s68, s68, 1
    s_and_b64 vcc, vcc, s[64:65]
    s_mov_b32 s59, vcc_lo
    s_and_b32 s64, vcc_lo, s60
    s_cmp_eq_u32 s64, s60
    s_cbranch_scc1 Lfdone_11
    s_sleep 2
    buffer_load_dwordx2 v[250:251], v252, s[52:55], 0 offen sc1
    s_waitcnt vmcnt(1)
    v_cmp_eq_u32 vcc, s66, v254
    v_cmp_eq_u32 s[64:65], s67, v255
    s_add_u32 s68, s68, 1
    s_and_b64 vcc, vcc, s[64:65]
    s_mov_b32 s59, vcc_lo
    s_and_b32 s64, vcc_lo, s60
    s_cmp_eq_u32 s64, s60
    s_cbranch_scc1 Lfdone_11
    s_cmp_ge_u32 s68, 0x20000
    s_cbranch_scc0 Lfpoll_10
Lfdone_11:
    s_mov_b64 exec, s[62:63]
Lfskip_12:
La2w_9:
    s_waitcnt vmcnt(0)
    s_barrier
    ds_read_b64_tr_b16 v[112:113], v8 offset:0
    ds_read_b64_tr_b16 v[114:115], v10 offset:512
    ds_read_b64_tr_b16 v[116:117], v9 offset:0
    ds_read_b64_tr_b16 v[118:119], v11 offset:512
    ds_read_b64_tr_b16 v[120:121], v10 offset:0
    ds_read_b64_tr_b16 v[122:123], v8 offset:512
    ds_read_b64_tr_b16 v[124:125], v11 offset:0
    ds_read_b64_tr_b16 v[126:127], v9 offset:512
    s_mov_b32 s10, 0
    buffer_load_dwordx4 v[32:35], v6, s[48:51], s10 offen offset:0 sc1
    s_mov_b32 s10, 0
    buffer_load_dwordx4 v[36:39], v6, s[48:51], s10 offen offset:1024 sc1
    s_mov_b32 s10, 0
    buffer_load_dwordx4 v[40:43], v6, s[48:51], s10 offen offset:2048 sc1
    s_mov_b32 s10, 0
    buffer_load_dwordx4 v[44:47], v6, s[48:51], s10 offen offset:3072 sc1
    s_mov_b32 s10, 4096
    buffer_load_dwordx4 v[48:51], v6, s[48:51], s10 offen offset:0 sc1
    s_cmp_lg_u32 s6, 0
    s_cbranch_scc1 La2w_13
    s_and_b32 s60, s61, 0xf000f0
    s_and_b32 s64, s59, s60
    s_cmp_eq_u32 s64, s60
    s_cbranch_scc1 Lfskip_16
    s_mov_b64 s[62:63], exec
    s_mov_b64 exec, 0xffffffff
    v_lshlrev_b32 v252, 3, v0
    v_add_u32 v252, s69, v252
    s_mov_b32 s68, 0
    buffer_load_dwordx2 v[250:251], v252, s[52:55], 0 offen sc1
Lfpoll_14:
    s_sleep 2
    buffer_load_dwordx2 v[254:255], v252, s[52:55], 0 offen sc1
    s_waitcnt vmcnt(1)
    v_cmp_eq_u32 vcc, s66, v250
    v_cmp_eq_u32 s[64:65], s67, v251
    s_add_u32 s68, s68, 1
    s_and_b64 vcc, vcc, s[64:65]
    s_mov_b32 s59, vcc_lo
    s_and_b32 s64, vcc_lo, s60
    s_cmp_eq_u32 s64, s60
    s_cbranch_scc1 Lfdone_15
    s_sleep 2
    buffer_load_dwordx2 v[250:251], v252, s[52:55], 0 offen sc1
    s_waitcnt vmcnt(1)
    v_cmp_eq_u32 vcc, s66, v254
    v_cmp_eq_u32 s[64:65], s67, v255
    s_add_u32 s68, s68, 1
    s_and_b64 vcc, vcc, s[64:65]
    s_mov_b32 s59, vcc_lo
    s_and_b32 s64, vcc_lo, s60
    s_cmp_eq_u32 s64, s60
    s_cbranch_scc1 Lfdone_15
    s_cmp_ge_u32 s68, 0x20000
    s_cbranch_scc0 Lfpoll_14
Lfdone_15:
    s_mov_b64 exec, s[62:63]
Lfskip_16:
La2w_13:
    s_nop 0
    s_barrier
    s_mov_b32 s10, 4096
    buffer_load_dwordx4 v[52:55], v6, s[48:51], s10 offen offset:1024 sc1
    s_mov_b32 s10, 4096
    buffer_load_dwordx4 v[56:59], v6, s[48:51], s10 offen offset:2048 sc1
    s_mov_b32 s10, 4096
    buffer_load_dwordx4 v[60:63], v6, s[48:51], s10 offen offset:3072 sc1
    s_mov_b32 s10, 8192
    buffer_load_dwordx4 v[64:67], v6, s[48:51], s10 offen offset:0 sc1
    s_mov_b32 s10, 8192
    buffer_load_dwordx4 v[68:71], v6, s[48:51], s10 offen offset:1024 sc1
    s_waitcnt vmcnt(9) lgkmcnt(0)
    v_mfma_f32_16x16x32_bf16 v[16:19], v[112:115], v[32:35], 0
    ds_read_b64_tr_b16 v[128:129], v8 offset:1024
    ds_read_b64_tr_b16 v[130:131], v10 offset:1536
    v_mfma_f32_16x16x32_bf16 v[20:23], v[116:119], v[32:35], 0
    ds_read_b64_tr_b16 v[132:133], v9 offset:1024
    ds_read_b64_tr_b16 v[134:135], v11 offset:1536
    v_mfma_f32_16x16x32_bf16 v[24:27], v[120:123], v[32:35], 0
    ds_read_b64_tr_b16 v[136:137], v10 offset:1024
    ds_read_b64_tr_b16 v[138:139], v8 offset:1536
    v_mfma_f32_16x16x32_bf16 v[28:31], v[124:127], v[32:35], 0
    ds_read_b64_tr_b16 v[140:141], v11 offset:1024
    ds_read_b64_tr_b16 v[142:143], v9 offset:1536
    s_waitcnt vmcnt(8) lgkmcnt(0)
    v_mfma_f32_16x16x32_bf16 v[16:19], v[128:131], v[36:39], v[16:19]
    ds_read_b64_tr_b16 v[112:113], v10 offset:2560
    ds_read_b64_tr_b16 v[114:115], v8 offset:3072
    v_mfma_f32_16x16x32_bf16 v[20:23], v[132:135], v[36:39], v[20:23]
    ds_read_b64_tr_b16 v[116:117], v11 offset:2560
    ds_read_b64_tr_b16 v[118:119], v9 offset:3072
    v_mfma_f32_16x16x32_bf16 v[24:27], v[136:139], v[36:39], v[24:27]
    ds_read_b64_tr_b16 v[120:121], v8 offset:2560
    ds_read_b64_tr_b16 v[122:123], v10 offset:3072
    v_mfma_f32_16x16x32_bf16 v[28:31], v[140:143], v[36:39], v[28:31]
    ds_read_b64_tr_b16 v[124:125], v9 offset:2560
    ds_read_b64_tr_b16 v[126:127], v11 offset:3072
    s_waitcnt vmcnt(7) lgkmcnt(0)
    v_mfma_f32_16x16x32_bf16 v[16:19], v[112:115], v[40:43], v[16:19]
    ds_read_b64_tr_b16 v[128:129], v10 offset:3584
    ds_read_b64_tr_b16 v[130:131], v8 offset:4096
    v_mfma_f32_16x16x32_bf16 v[20:23], v[116:119], v[40:43], v[20:23]
    ds_read_b64_tr_b16 v[132:133], v11 offset:3584
    ds_read_b64_tr_b16 v[134:135], v9 offset:4096
    v_mfma_f32_16x16x32_bf16 v[24:27], v[120:123], v[40:43], v[24:27]
    ds_read_b64_tr_b16 v[136:137], v8 offset:3584
    ds_read_b64_tr_b16 v[138:139], v10 offset:4096
    v_mfma_f32_16x16x32_bf16 v[28:31], v[124:127], v[40:43], v[28:31]
    ds_read_b64_tr_b16 v[140:141], v9 offset:3584
    ds_read_b64_tr_b16 v[142:143], v11 offset:4096
    s_waitcnt vmcnt(6) lgkmcnt(0)
    v_mfma_f32_16x16x32_bf16 v[16:19], v[128:131], v[44:47], v[16:19]
    ds_read_b64_tr_b16 v[112:113], v8 offset:2048
    ds_read_b64_tr_b16 v[114:115], v8 offset:2048
    v_mfma_f32_16x16x32_bf16 v[20:23], v[132:135], v[44:47], v[20:23]
    ds_read_b64_tr_b16 v[116:117], v9 offset:2048
    ds_read_b64_tr_b16 v[118:119], v9 offset:2048
    v_mfma_f32_16x16x32_bf16 v[24:27], v[136:139], v[44:47], v[24:27]
    ds_read_b64_tr_b16 v[120:121], v10 offset:2048
    ds_read_b64_tr_b16 v[122:123], v10 offset:2048
    v_mfma_f32_16x16x32_bf16 v[28:31], v[140:143], v[44:47], v[28:31]
    ds_read_b64_tr_b16 v[124:125], v11 offset:2048
    ds_read_b64_tr_b16 v[126:127], v11 offset:2048
    s_waitcnt vmcnt(5) lgkmcnt(0)
    v_mfma_f32_16x16x32_bf16 v[16:19], v[112:115], v[48:51], v[16:19]
    ds_read_b64_tr_b16 v[128:129], v8 offset:18432
    ds_read_b64_tr_b16 v[130:131], v10 offset:18944
    v_mfma_f32_16x16x32_bf16 v[20:23], v[116:119], v[48:51], v[20:23]
    ds_read_b64_tr_b16 v[132:133], v9 offset:18432
    ds_read_b64_tr_b16 v[134:135], v11 offset:18944
    v_mfma_f32_16x16x32_bf16 v[24:27], v[120:123], v[48:51], v[24:27]
    ds_read_b64_tr_b16 v[136:137], v10 offset:18432
    ds_read_b64_tr_b16 v[138:139], v8 offset:18944
    v_mfma_f32_16x16x32_bf16 v[28:31], v[124:127], v[48:51], v[28:31]
    ds_read_b64_tr_b16 v[140:141], v11 offset:18432
    ds_read_b64_tr_b16 v[142:143], v9 offset:18944
    s_cmp_lg_u32 s6, 0
    s_cbranch_scc1 La2w_17
    s_and_b32 s60, s61, 0xf000f00
    s_and_b32 s64, s59, s60
    s_cmp_eq_u32 s64, s60
    s_cbranch_scc1 Lfskip_20
    s_mov_b64 s[62:63], exec
    s_mov_b64 exec, 0xffffffff
    v_lshlrev_b32 v252, 3, v0
    v_add_u32 v252, s69, v252
    s_mov_b32 s68, 0
    buffer_load_dwordx2 v[250:251], v252, s[52:55], 0 offen sc1
Lfpoll_18:
    s_sleep 2
    buffer_load_dwordx2 v[254:255], v252, s[52:55], 0 offen sc1
    s_waitcnt vmcnt(1)
    v_cmp_eq_u32 vcc, s66, v250
    v_cmp_eq_u32 s[64:65], s67, v251
    s_add_u32 s68, s68, 1
    s_and_b64 vcc, vcc, s[64:65]
    s_mov_b32 s59, vcc_lo
    s_and_b32 s64, vcc_lo, s60
    s_cmp_eq_u32 s64, s60
    s_cbranch_scc1 Lfdone_19
    s_sleep 2
    buffer_load_dwordx2 v[250:251], v252, s[52:55], 0 offen sc1
    s_waitcnt vmcnt(1)
    v_cmp_eq_u32 vcc, s66, v254
    v_cmp_eq_u32 s[64:65], s67, v255
    s_add_u32 s68, s68, 1
    s_and_b64 vcc, vcc, s[64:65]
    s_mov_b32 s59, vcc_lo
    s_and_b32 s64, vcc_lo, s60
    s_cmp_eq_u32 s64, s60
    s_cbranch_scc1 Lfdone_19
    s_cmp_ge_u32 s68, 0x20000
    s_cbranch_scc0 Lfpoll_18
Lfdone_19:
    s_mov_b64 exec, s[62:63]
Lfskip_20:
La2w_17:
    s_nop 0
    s_barrier
    s_mov_b32 s10, 8192
    buffer_load_dwordx4 v[72:75], v6, s[48:51], s10 offen offset:2048 sc1
    s_mov_b32 s10, 8192
    buffer_load_dwordx4 v[76:79], v6, s[48:51], s10 offen offset:3072 sc1
    s_mov_b32 s10, 12288
    buffer_load_dwordx4 v[80:83], v6, s[48:51], s10 offen offset:0 sc1
    s_mov_b32 s10, 12288
    buffer_load_dwordx4 v[84:87], v6, s[48:51], s10 offen offset:1024 sc1
    s_mov_b32 s10, 12288
    buffer_load_dwordx4 v[88:91], v6, s[48:51], s10 offen offset:2048 sc1
    s_waitcnt vmcnt(9) lgkmcnt(0)
    v_mfma_f32_16x16x32_bf16 v[16:19], v[128:131], v[52:55], v[16:19]
    ds_read_b64_tr_b16 v[112:113], v8 offset:19456
    ds_read_b64_tr_b16 v[114:115], v10 offset:19968
    v_mfma_f32_16x16x32_bf16 v[20:23], v[132:135], v[52:55], v[20:23]
    ds_read_b64_tr_b16 v[116:117], v9 offset:19456
    ds_read_b64_tr_b16 v[118:119], v11 offset:19968
    v_mfma_f32_16x16x32_bf16 v[24:27], v[136:139], v[52:55], v[24:27]
    ds_read_b64_tr_b16 v[120:121], v10 offset:19456
    ds_read_b64_tr_b16 v[122:123], v8 offset:19968
    v_mfma_f32_16x16x32_bf16 v[28:31], v[140:143], v[52:55], v[28:31]
    ds_read_b64_tr_b16 v[124:125], v11 offset:19456
    ds_read_b64_tr_b16 v[126:127], v9 offset:19968
    s_waitcnt vmcnt(8) lgkmcnt(0)
    v_mfma_f32_16x16x32_bf16 v[16:19], v[112:115], v[56:59], v[16:19]
    ds_read_b64_tr_b16 v[128:129], v10 offset:20992
    ds_read_b64_tr_b16 v[130:131], v8 offset:21504
    v_mfma_f32_16x16x32_bf16 v[20:23], v[116:119], v[56:59], v[20:23]
    ds_read_b64_tr_b16 v[132:133], v11 offset:20992
    ds_read_b64_tr_b16 v[134:135], v9 offset:21504
    v_mfma_f32_16x16x32_bf16 v[24:27], v[120:123], v[56:59], v[24:27]
    ds_read_b64_tr_b16 v[136:137], v8 offset:20992
    ds_read_b64_tr_b16 v[138:139], v10 offset:21504
    v_mfma_f32_16x16x32_bf16 v[28:31], v[124:127], v[56:59], v[28:31]
    ds_read_b64_tr_b16 v[140:141], v9 offset:20992
    ds_read_b64_tr_b16 v[142:143], v11 offset:21504
    s_waitcnt vmcnt(7) lgkmcnt(0)
    v_mfma_f32_16x16x32_bf16 v[16:19], v[128:131], v[60:63], v[16:19]
    ds_read_b64_tr_b16 v[112:113], v10 offset:22016
    ds_read_b64_tr_b16 v[114:115], v8 offset:22528
    v_mfma_f32_16x16x32_bf16 v[20:23], v[132:135], v[60:63], v[20:23]
    ds_read_b64_tr_b16 v[116:117], v11 offset:22016
    ds_read_b64_tr_b16 v[118:119], v9 offset:22528
    v_mfma_f32_16x16x32_bf16 v[24:27], v[136:139], v[60:63], v[24:27]
    ds_read_b64_tr_b16 v[120:121], v8 offset:22016
    ds_read_b64_tr_b16 v[122:123], v10 offset:22528
    v_mfma_f32_16x16x32_bf16 v[28:31], v[140:143], v[60:63], v[28:31]
    ds_read_b64_tr_b16 v[124:125], v9 offset:22016
    ds_read_b64_tr_b16 v[126:127], v11 offset:22528
    s_waitcnt vmcnt(6) lgkmcnt(0)
    v_mfma_f32_16x16x32_bf16 v[16:19], v[112:115], v[64:67], v[16:19]
    ds_read_b64_tr_b16 v[128:129], v8 offset:20480
    ds_read_b64_tr_b16 v[130:131], v8 offset:20480
    v_mfma_f32_16x16x32_bf16 v[20:23], v[116:119], v[64:67], v[20:23]
    ds_read_b64_tr_b16 v[132:133], v9 offset:20480
    ds_read_b64_tr_b16 v[134:135], v9 offset:20480
    v_mfma_f32_16x16x32_bf16 v[24:27], v[120:123], v[64:67], v[24:27]
    ds_read_b64_tr_b16 v[136:137], v10 offset:20480
    ds_read_b64_tr_b16 v[138:139], v10 offset:20480
    v_mfma_f32_16x16x32_bf16 v[28:31], v[124:127], v[64:67], v[28:31]
    ds_read_b64_tr_b16 v[140:141], v11 offset:20480
    ds_read_b64_tr_b16 v[142:143], v11 offset:20480
    s_waitcnt vmcnt(5) lgkmcnt(0)
    v_mfma_f32_16x16x32_bf16 v[16:19], v[128:131], v[68:71], v[16:19]
    ds_read_b64_tr_b16 v[112:113], v8 offset:36864
    ds_read_b64_tr_b16 v[114:115], v10 offset:37376
    v_mfma_f32_16x16x32_bf16 v[20:23], v[132:135], v[68:71], v[20:23]
    ds_read_b64_tr_b16 v[116:117], v9 offset:36864
    ds_read_b64_tr_b16 v[118:119], v11 offset:37376
    v_mfma_f32_16x16x32_bf16 v[24:27], v[136:139], v[68:71], v[24:27]
    ds_read_b64_tr_b16 v[120:121], v10 offset:36864
    ds_read_b64_tr_b16 v[122:123], v8 offset:37376
    v_mfma_f32_16x16x32_bf16 v[28:31], v[140:143], v[68:71], v[28:31]
    ds_read_b64_tr_b16 v[124:125], v11 offset:36864
    ds_read_b64_tr_b16 v[126:127], v9 offset:37376
    s_cmp_lg_u32 s6, 0
    s_cbranch_scc1 La2w_21
    s_and_b32 s60, s61, 0xf000f000
    s_and_b32 s64, s59, s60
    s_cmp_eq_u32 s64, s60
    s_cbranch_scc1 Lfskip_24
    s_mov_b64 s[62:63], exec
    s_mov_b64 exec, 0xffffffff
    v_lshlrev_b32 v252, 3, v0
    v_add_u32 v252, s69, v252
    s_mov_b32 s68, 0
    buffer_load_dwordx2 v[250:251], v252, s[52:55], 0 offen sc1
Lfpoll_22:
    s_sleep 2
    buffer_load_dwordx2 v[254:255], v252, s[52:55], 0 offen sc1
    s_waitcnt vmcnt(1)
    v_cmp_eq_u32 vcc, s66, v250
    v_cmp_eq_u32 s[64:65], s67, v251
    s_add_u32 s68, s68, 1
    s_and_b64 vcc, vcc, s[64:65]
    s_mov_b32 s59, vcc_lo
    s_and_b32 s64, vcc_lo, s60
    s_cmp_eq_u32 s64, s60
    s_cbranch_scc1 Lfdone_23
    s_sleep 2
    buffer_load_dwordx2 v[250:251], v252, s[52:55], 0 offen sc1
    s_waitcnt vmcnt(1)
    v_cmp_eq_u32 vcc, s66, v254
    v_cmp_eq_u32 s[64:65], s67, v255
    s_add_u32 s68, s68, 1
    s_and_b64 vcc, vcc, s[64:65]
    s_mov_b32 s59, vcc_lo
    s_and_b32 s64, vcc_lo, s60
    s_cmp_eq_u32 s64, s60
    s_cbranch_scc1 Lfdone_23
    s_cmp_ge_u32 s68, 0x20000
    s_cbranch_scc0 Lfpoll_22
Lfdone_23:
    s_mov_b64 exec, s[62:63]
Lfskip_24:
La2w_21:
    s_nop 0
    s_barrier
    s_mov_b32 s10, 12288
    buffer_load_dwordx4 v[92:95], v6, s[48:51], s10 offen offset:3072 sc1
    s_mov_b32 s10, 16384
    buffer_load_dwordx4 v[96:99], v6, s[48:51], s10 offen offset:0 sc1
    s_mov_b32 s10, 16384
    buffer_load_dwordx4 v[100:103], v6, s[48:51], s10 offen offset:1024 sc1
    s_mov_b32 s10, 16384
    buffer_load_dwordx4 v[104:107], v6, s[48:51], s10 offen offset:2048 sc1
    s_mov_b32 s10, 16384
    buffer_load_dwordx4 v[108:111], v6, s[48:51], s10 offen offset:3072 sc1
    s_waitcnt vmcnt(9) lgkmcnt(0)
    v_mfma_f32_16x16x32_bf16 v[16:19], v[112:115], v[72:75], v[16:19]
    ds_read_b64_tr_b16 v[128:129], v8 offset:37888
    ds_read_b64_tr_b16 v[130:131], v10 offset:38400
    v_mfma_f32_16x16x32_bf16 v[20:23], v[116:119], v[72:75], v[20:23]
    ds_read_b64_tr_b16 v[132:133], v9 offset:37888
    ds_read_b64_tr_b16 v[134:135], v11 offset:38400
    v_mfma_f32_16x16x32_bf16 v[24:27], v[120:123], v[72:75], v[24:27]
    ds_read_b64_tr_b16 v[136:137], v10 offset:37888
    ds_read_b64_tr_b16 v[138:139], v8 offset:38400
    v_mfma_f32_16x16x32_bf16 v[28:31], v[124:127], v[72:75], v[28:31]
    ds_read_b64_tr_b16 v[140:141], v11 offset:37888
    ds_read_b64_tr_b16 v[142:143], v9 offset:38400
    s_waitcnt vmcnt(8) lgkmcnt(0)
    v_mfma_f32_16x16x32_bf16 v[16:19], v[128:131], v[76:79], v[16:19]
    ds_read_b64_tr_b16 v[112:113], v10 offset:39424
    ds_read_b64_tr_b16 v[114:115], v8 offset:39936
    v_mfma_f32_16x16x32_bf16 v[20:23], v[132:135], v[76:79], v[20:23]
    ds_read_b64_tr_b16 v[116:117], v11 offset:39424
    ds_read_b64_tr_b16 v[118:119], v9 offset:39936
    v_mfma_f32_16x16x32_bf16 v[24:27], v[136:139], v[76:79], v[24:27]
    ds_read_b64_tr_b16 v[120:121], v8 offset:39424
    ds_read_b64_tr_b16 v[122:123], v10 offset:39936
    v_mfma_f32_16x16x32_bf16 v[28:31], v[140:143], v[76:79], v[28:31]
    ds_read_b64_tr_b16 v[124:125], v9 offset:39424
    ds_read_b64_tr_b16 v[126:127], v11 offset:39936
    s_waitcnt vmcnt(7) lgkmcnt(0)
    v_mfma_f32_16x16x32_bf16 v[16:19], v[112:115], v[80:83], v[16:19]
    ds_read_b64_tr_b16 v[128:129], v10 offset:40448
    ds_read_b64_tr_b16 v[130:131], v8 offset:40960
    v_mfma_f32_16x16x32_bf16 v[20:23], v[116:119], v[80:83], v[20:23]
    ds_read_b64_tr_b16 v[132:133], v11 offset:40448
    ds_read_b64_tr_b16 v[134:135], v9 offset:40960
    v_mfma_f32_16x16x32_bf16 v[24:27], v[120:123], v[80:83], v[24:27]
    ds_read_b64_tr_b16 v[136:137], v8 offset:40448
    ds_read_b64_tr_b16 v[138:139], v10 offset:40960
    v_mfma_f32_16x16x32_bf16 v[28:31], v[124:127], v[80:83], v[28:31]
    ds_read_b64_tr_b16 v[140:141], v9 offset:40448
    ds_read_b64_tr_b16 v[142:143], v11 offset:40960
    s_waitcnt vmcnt(6) lgkmcnt(0)
    v_mfma_f32_16x16x32_bf16 v[16:19], v[128:131], v[84:87], v[16:19]
    ds_read_b64_tr_b16 v[112:113], v8 offset:38912
    ds_read_b64_tr_b16 v[114:115], v8 offset:38912
    v_mfma_f32_16x16x32_bf16 v[20:23], v[132:135], v[84:87], v[20:23]
    ds_read_b64_tr_b16 v[116:117], v9 offset:38912
    ds_read_b64_tr_b16 v[118:119], v9 offset:38912
    v_mfma_f32_16x16x32_bf16 v[24:27], v[136:139], v[84:87], v[24:27]
    ds_read_b64_tr_b16 v[120:121], v10 offset:38912
    ds_read_b64_tr_b16 v[122:123], v10 offset:38912
    v_mfma_f32_16x16x32_bf16 v[28:31], v[140:143], v[84:87], v[28:31]
    ds_read_b64_tr_b16 v[124:125], v11 offset:38912
    ds_read_b64_tr_b16 v[126:127], v11 offset:38912
    s_waitcnt vmcnt(5) lgkmcnt(0)
    v_mfma_f32_16x16x32_bf16 v[16:19], v[112:115], v[88:91], v[16:19]
    ds_read_b64_tr_b16 v[128:129], v8 offset:55296
    ds_read_b64_tr_b16 v[130:131], v10 offset:55808
    v_mfma_f32_16x16x32_bf16 v[20:23], v[116:119], v[88:91], v[20:23]
    ds_read_b64_tr_b16 v[132:133], v9 offset:55296
    ds_read_b64_tr_b16 v[134:135], v11 offset:55808
    v_mfma_f32_16x16x32_bf16 v[24:27], v[120:123], v[88:91], v[24:27]
    ds_read_b64_tr_b16 v[136:137], v10 offset:55296
    ds_read_b64_tr_b16 v[138:139], v8 offset:55808
    v_mfma_f32_16x16x32_bf16 v[28:31], v[124:127], v[88:91], v[28:31]
    ds_read_b64_tr_b16 v[140:141], v11 offset:55296
    ds_read_b64_tr_b16 v[142:143], v9 offset:55808
    s_waitcnt vmcnt(4) lgkmcnt(0)
    v_mfma_f32_16x16x32_bf16 v[16:19], v[128:131], v[92:95], v[16:19]
    ds_read_b64_tr_b16 v[112:113], v8 offset:56320
    ds_read_b64_tr_b16 v[114:115], v10 offset:56832
    v_mfma_f32_16x16x32_bf16 v[20:23], v[132:135], v[92:95], v[20:23]
    ds_read_b64_tr_b16 v[116:117], v9 offset:56320
    ds_read_b64_tr_b16 v[118:119], v11 offset:56832
    v_mfma_f32_16x16x32_bf16 v[24:27], v[136:139], v[92:95], v[24:27]
    ds_read_b64_tr_b16 v[120:121], v10 offset:56320
    ds_read_b64_tr_b16 v[122:123], v8 offset:56832
    v_mfma_f32_16x16x32_bf16 v[28:31], v[140:143], v[92:95], v[28:31]
    ds_read_b64_tr_b16 v[124:125], v11 offset:56320
    ds_read_b64_tr_b16 v[126:127], v9 offset:56832
    s_waitcnt vmcnt(3) lgkmcnt(0)
    v_mfma_f32_16x16x32_bf16 v[16:19], v[112:115], v[96:99], v[16:19]
    ds_read_b64_tr_b16 v[128:129], v10 offset:57856
    ds_read_b64_tr_b16 v[130:131], v8 offset:58368
    v_mfma_f32_16x16x32_bf16 v[20:23], v[116:119], v[96:99], v[20:23]
    ds_read_b64_tr_b16 v[132:133], v11 offset:57856
    ds_read_b64_tr_b16 v[134:135], v9 offset:58368
    v_mfma_f32_16x16x32_bf16 v[24:27], v[120:123], v[96:99], v[24:27]
    ds_read_b64_tr_b16 v[136:137], v8 offset:57856
    ds_read_b64_tr_b16 v[138:139], v10 offset:58368
    v_mfma_f32_16x16x32_bf16 v[28:31], v[124:127], v[96:99], v[28:31]
    ds_read_b64_tr_b16 v[140:141], v9 offset:57856
    ds_read_b64_tr_b16 v[142:143], v11 offset:58368
    s_waitcnt vmcnt(2) lgkmcnt(0)
    v_mfma_f32_16x16x32_bf16 v[16:19], v[128:131], v[100:103], v[16:19]
    ds_read_b64_tr_b16 v[112:113], v10 offset:58880
    ds_read_b64_tr_b16 v[114:115], v8 offset:59392
    v_mfma_f32_16x16x32_bf16 v[20:23], v[132:135], v[100:103], v[20:23]
    ds_read_b64_tr_b16 v[116:117], v11 offset:58880
    ds_read_b64_tr_b16 v[118:119], v9 offset:59392
    v_mfma_f32_16x16x32_bf16 v[24:27], v[136:139], v[100:103], v[24:27]
    ds_read_b64_tr_b16 v[120:121], v8 offset:58880
    ds_read_b64_tr_b16 v[122:123], v10 offset:59392
    v_mfma_f32_16x16x32_bf16 v[28:31], v[140:143], v[100:103], v[28:31]
    ds_read_b64_tr_b16 v[124:125], v9 offset:58880
    ds_read_b64_tr_b16 v[126:127], v11 offset:59392
    s_waitcnt vmcnt(1) lgkmcnt(0)
    v_mfma_f32_16x16x32_bf16 v[16:19], v[112:115], v[104:107], v[16:19]
    ds_read_b64_tr_b16 v[128:129], v8 offset:57344
    ds_read_b64_tr_b16 v[130:131], v8 offset:57344
    v_mfma_f32_16x16x32_bf16 v[20:23], v[116:119], v[104:107], v[20:23]
    ds_read_b64_tr_b16 v[132:133], v9 offset:57344
    ds_read_b64_tr_b16 v[134:135], v9 offset:57344
    v_mfma_f32_16x16x32_bf16 v[24:27], v[120:123], v[104:107], v[24:27]
    ds_read_b64_tr_b16 v[136:137], v10 offset:57344
    ds_read_b64_tr_b16 v[138:139], v10 offset:57344
    v_mfma_f32_16x16x32_bf16 v[28:31], v[124:127], v[104:107], v[28:31]
    ds_read_b64_tr_b16 v[140:141], v11 offset:57344
    ds_read_b64_tr_b16 v[142:143], v11 offset:57344
    s_waitcnt vmcnt(0) lgkmcnt(0)
    v_mfma_f32_16x16x32_bf16 v[16:19], v[128:131], v[108:111], v[16:19]
    v_mfma_f32_16x16x32_bf16 v[20:23], v[132:135], v[108:111], v[20:23]
    v_mfma_f32_16x16x32_bf16 v[24:27], v[136:139], v[108:111], v[24:27]
    v_mfma_f32_16x16x32_bf16 v[28:31], v[140:143], v[108:111], v[28:31]
    s_nop 7
    v_cvt_pk_bf16_f32 v112, v16, v17
    v_cvt_pk_bf16_f32 v113, v18, v19
    buffer_store_dwordx2 v[112:113], v3, s[40:43], 0 offen offset:0
    v_cvt_pk_bf16_f32 v114, v20, v21
    v_cvt_pk_bf16_f32 v115, v22, v23
    buffer_store_dwordx2 v[114:115], v3, s[40:43], 0 offen offset:32
    v_cvt_pk_bf16_f32 v116, v24, v25
    v_cvt_pk_bf16_f32 v117, v26, v27
    buffer_store_dwordx2 v[116:117], v3, s[40:43], 0 offen offset:64
    v_cvt_pk_bf16_f32 v118, v28, v29
    v_cvt_pk_bf16_f32 v119, v30, v31
    buffer_store_dwordx2 v[118:119], v3, s[40:43], 0 offen offset:96
    s_waitcnt vmcnt(0)
    s_endpgm
F_NOTA:
    s_cmp_ge_u32 s2, 248
    s_cbranch_scc1 F_SPARE
    s_sub_u32 s3, s2, 176
    s_and_b32 s4, s3, 7
    s_lshr_b32 s5, s3, 3
    s_mul_i32 s7, s4, 294912
    s_lshl_b32 s8, s5, 7
    s_add_u32 s7, s7, s8
    v_lshrrev_b32 v1, 5, v0
    v_and_b32 v2, 31, v0
    v_mul_u32_u24 v3, 18432, v1
    v_add_u32 v3, s7, v3
    v_lshl_add_u32 v3, v2, 2, v3
    v_subrev_u32 v4, 1152, v3
    v_subrev_u32 v5, 2304, v3
    v_subrev_u32 v6, 3456, v3
    v_add_u32 v8, 4608, v3
    v_add_u32 v9, 9216, v3
    v_add_u32 v10, 13824, v3
    s_lshl_b32 s8, s5, 9
    v_lshlrev_b32 v11, 4, v2
    v_add_u32 v11, s8, v11
    s_waitcnt lgkmcnt(0)
    s_mov_b32 s40, s24
    s_and_b32 s41, s25, 0xffff
    s_mov_b32 s42, 2359296
    s_mov_b32 s43, 0x00020000
    s_mov_b32 s44, s26
    s_and_b32 s45, s27, 0xffff
    s_mov_b32 s46, 2359296
    s_mov_b32 s47, 0x00020000
    s_mov_b32 s48, s28
    s_and_b32 s49, s29, 0xffff
    s_mov_b32 s50, 4608
    s_mov_b32 s51, 0x00020000
    buffer_load_dwordx4 v[56:59], v11, s[48:51], 0 offen
    buffer_load_dword v16, v6, s[40:43], 0 offen
    buffer_load_dword v17, v5, s[40:43], 0 offen
    buffer_load_dword v18, v4, s[40:43], 0 offen
    buffer_load_dword v19, v3, s[40:43], 0 offen offset:0
    buffer_load_dword v20, v3, s[40:43], 0 offen offset:1152
    buffer_load_dword v21, v3, s[40:43], 0 offen offset:2304
    buffer_load_dword v22, v3, s[40:43], 0 offen offset:3456
    buffer_load_dword v23, v8, s[40:43], 0 offen offset:0
    buffer_load_dword v24, v8, s[40:43], 0 offen offset:1152
    buffer_load_dword v25, v8, s[40:43], 0 offen offset:2304
    buffer_load_dword v26, v8, s[40:43], 0 offen offset:3456
    buffer_load_dword v27, v9, s[40:43], 0 offen offset:0
    buffer_load_dword v28, v9, s[40:43], 0 offen offset:1152
    buffer_load_dword v29, v9, s[40:43], 0 offen offset:2304
    buffer_load_dword v30, v9, s[40:43], 0 offen offset:3456
    buffer_load_dword v31, v10, s[40:43], 0 offen offset:0
    buffer_load_dword v32, v10, s[40:43], 0 offen offset:1152
    buffer_load_dword v33, v10, s[40:43], 0 offen offset:2304
    buffer_load_dword v34, v10, s[40:43], 0 offen offset:3456
    buffer_load_dword v36, v3, s[44:47], 0 offen offset:0
    buffer_load_dword v37, v3, s[44:47], 0 offen offset:1152
    buffer_load_dword v38, v3, s[44:47], 0 offen offset:2304
    buffer_load_dword v39, v3, s[44:47], 0 offen offset:3456
    buffer_load_dword v40, v8, s[44:47], 0 offen offset:0
    buffer_load_dword v41, v8, s[44:47], 0 offen offset:1152
    buffer_load_dword v42, v8, s[44:47], 0 offen offset:2304
    buffer_load_dword v43, v8, s[44:47], 0 offen offset:3456
    buffer_load_dword v44, v9, s[44:47], 0 offen offset:0
    buffer_load_dword v45, v9, s[44:47], 0 offen offset:1152
    buffer_load_dword v46, v9, s[44:47], 0 offen offset:2304
    buffer_load_dword v47, v9, s[44:47], 0 offen offset:3456
    buffer_load_dword v48, v10, s[44:47], 0 offen offset:0
    buffer_load_dword v49, v10, s[44:47], 0 offen offset:1152
    buffer_load_dword v50, v10, s[44:47], 0 offen offset:2304
    buffer_load_dword v51, v10, s[44:47], 0 offen offset:3456
    v_mov_b32 v60, v1
    v_mov_b32 v61, v2
    v_mov_b32 v1, v60
    v_mov_b32 v2, v61
    s_add_u32 s56, s38, 4194304
    s_addc_u32 s57, s39, 0
    s_and_b32 s57, s57, 0xffff
    s_mov_b32 s58, 2359296
    s_mov_b32 s59, 0x00020000
    v_lshrrev_b32 v12, 4, v2
    v_mul_u32_u24 v12, 17664, v12
    v_and_b32 v13, 15, v2
    v_mul_u32_u24 v13, 528, v13
    v_add_u32 v12, v12, v13
    v_lshlrev_b32 v13, 5, v1
    v_sub_u32 v12, v12, v13
    v_add_u32 v12, 8944, v12
    v_subrev_u32 v13, 16, v12
    s_mov_b32 s9, 0xffff0000
    s_waitcnt vmcnt(16)
    v_lshlrev_b32 v64, 16, v16
    v_and_b32 v65, s9, v16
    v_lshlrev_b32 v66, 16, v17
    v_and_b32 v67, s9, v17
    v_lshlrev_b32 v68, 16, v18
    v_and_b32 v69, s9, v18
    v_lshlrev_b32 v70, 16, v19
    v_and_b32 v71, s9, v19
    v_lshlrev_b32 v72, 16, v20
    v_and_b32 v73, s9, v20
    v_lshlrev_b32 v74, 16, v21
    v_and_b32 v75, s9, v21
    v_lshlrev_b32 v76, 16, v22
    v_and_b32 v77, s9, v22
    v_lshlrev_b32 v78, 16, v23
    v_and_b32 v79, s9, v23
    v_lshlrev_b32 v80, 16, v24
    v_and_b32 v81, s9, v24
    v_lshlrev_b32 v82, 16, v25
    v_and_b32 v83, s9, v25
    v_lshlrev_b32 v84, 16, v26
    v_and_b32 v85, s9, v26
    v_lshlrev_b32 v86, 16, v27
    v_and_b32 v87, s9, v27
    v_lshlrev_b32 v88, 16, v28
    v_and_b32 v89, s9, v28
    v_lshlrev_b32 v90, 16, v29
    v_and_b32 v91, s9, v29
    v_lshlrev_b32 v92, 16, v30
    v_and_b32 v93, s9, v30
    v_lshlrev_b32 v94, 16, v31
    v_and_b32 v95, s9, v31
    v_lshlrev_b32 v96, 16, v32
    v_and_b32 v97, s9, v32
    v_lshlrev_b32 v98, 16, v33
    v_and_b32 v99, s9, v33
    v_lshlrev_b32 v100, 16, v34
    v_and_b32 v101, s9, v34
    v_lshlrev_b32 v104, 16, v56
    v_lshlrev_b32 v105, 16, v58
    v_and_b32 v106, s9, v56
    v_and_b32 v107, s9, v58
    v_lshlrev_b32 v108, 16, v57
    v_lshlrev_b32 v109, 16, v59
    v_and_b32 v110, s9, v57
    v_and_b32 v111, s9, v59
    v_pk_mul_f32 v[112:113], v[64:65], v[110:111]
    v_pk_mul_f32 v[114:115], v[66:67], v[110:111]
    v_pk_mul_f32 v[116:117], v[68:69], v[110:111]
    v_pk_mul_f32 v[118:119], v[70:71], v[110:111]
    v_pk_mul_f32 v[120:121], v[72:73], v[110:111]
    v_pk_mul_f32 v[122:123], v[74:75], v[110:111]
    v_pk_mul_f32 v[124:125], v[76:77], v[110:111]
    v_pk_mul_f32 v[126:127], v[78:79], v[110:111]
    v_pk_mul_f32 v[128:129], v[80:81], v[110:111]
    v_pk_mul_f32 v[130:131], v[82:83], v[110:111]
    v_pk_mul_f32 v[132:133], v[84:85], v[110:111]
    v_pk_mul_f32 v[134:135], v[86:87], v[110:111]
    v_pk_mul_f32 v[136:137], v[88:89], v[110:111]
    v_pk_mul_f32 v[138:139], v[90:91], v[110:111]
    v_pk_mul_f32 v[140:141], v[92:93], v[110:111]
    v_pk_mul_f32 v[142:143], v[94:95], v[110:111]
    v_pk_fma_f32 v[112:113], v[66:67], v[108:109], v[112:113]
    v_pk_fma_f32 v[114:115], v[68:69], v[108:109], v[114:115]
    v_pk_fma_f32 v[116:117], v[70:71], v[108:109], v[116:117]
    v_pk_fma_f32 v[118:119], v[72:73], v[108:109], v[118:119]
    v_pk_fma_f32 v[120:121], v[74:75], v[108:109], v[120:121]
    v_pk_fma_f32 v[122:123], v[76:77], v[108:109], v[122:123]
    v_pk_fma_f32 v[124:125], v[78:79], v[108:109], v[124:125]
    v_pk_fma_f32 v[126:127], v[80:81], v[108:109], v[126:127]
    v_pk_fma_f32 v[128:129], v[82:83], v[108:109], v[128:129]
    v_pk_fma_f32 v[130:131], v[84:85], v[108:109], v[130:131]
    v_pk_fma_f32 v[132:133], v[86:87], v[108:109], v[132:133]
    v_pk_fma_f32 v[134:135], v[88:89], v[108:109], v[134:135]
    v_pk_fma_f32 v[136:137], v[90:91], v[108:109], v[136:137]
    v_pk_fma_f32 v[138:139], v[92:93], v[108:109], v[138:139]
    v_pk_fma_f32 v[140:141], v[94:95], v[108:109], v[140:141]
    v_pk_fma_f32 v[142:143], v[96:97], v[108:109], v[142:143]
    v_pk_fma_f32 v[112:113], v[68:69], v[106:107], v[112:113]
    v_pk_fma_f32 v[114:115], v[70:71], v[106:107], v[114:115]
    v_pk_fma_f32 v[116:117], v[72:73], v[106:107], v[116:117]
    v_pk_fma_f32 v[118:119], v[74:75], v[106:107], v[118:119]
    v_pk_fma_f32 v[120:121], v[76:77], v[106:107], v[120:121]
    v_pk_fma_f32 v[122:123], v[78:79], v[106:107], v[122:123]
    v_pk_fma_f32 v[124:125], v[80:81], v[106:107], v[124:125]
    v_pk_fma_f32 v[126:127], v[82:83], v[106:107], v[126:127]
    v_pk_fma_f32 v[128:129], v[84:85], v[106:107], v[128:129]
    v_pk_fma_f32 v[130:131], v[86:87], v[106:107], v[130:131]
    v_pk_fma_f32 v[132:133], v[88:89], v[106:107], v[132:133]
    v_pk_fma_f32 v[134:135], v[90:91], v[106:107], v[134:135]
    v_pk_fma_f32 v[136:137], v[92:93], v[106:107], v[136:137]
    v_pk_fma_f32 v[138:139], v[94:95], v[106:107], v[138:139]
    v_pk_fma_f32 v[140:141], v[96:97], v[106:107], v[140:141]
    v_pk_fma_f32 v[142:143], v[98:99], v[106:107], v[142:143]
    v_pk_fma_f32 v[112:113], v[70:71], v[104:105], v[112:113]
    v_pk_fma_f32 v[114:115], v[72:73], v[104:105], v[114:115]
    v_pk_fma_f32 v[116:117], v[74:75], v[104:105], v[116:117]
    v_pk_fma_f32 v[118:119], v[76:77], v[104:105], v[118:119]
    v_pk_fma_f32 v[120:121], v[78:79], v[104:105], v[120:121]
    v_pk_fma_f32 v[122:123], v[80:81], v[104:105], v[122:123]
    v_pk_fma_f32 v[124:125], v[82:83], v[104:105], v[124:125]
    v_pk_fma_f32 v[126:127], v[84:85], v[104:105], v[126:127]
    v_pk_fma_f32 v[128:129], v[86:87], v[104:105], v[128:129]
    v_pk_fma_f32 v[130:131], v[88:89], v[104:105], v[130:131]
    v_pk_fma_f32 v[132:133], v[90:91], v[104:105], v[132:133]
    v_pk_fma_f32 v[134:135], v[92:93], v[104:105], v[134:135]
    v_pk_fma_f32 v[136:137], v[94:95], v[104:105], v[136:137]
    v_pk_fma_f32 v[138:139], v[96:97], v[104:105], v[138:139]
    v_pk_fma_f32 v[140:141], v[98:99], v[104:105], v[140:141]
    v_pk_fma_f32 v[142:143], v[100:101], v[104:105], v[142:143]
    s_waitcnt vmcnt(0)
    v_lshlrev_b32 v64, 16, v36
    v_and_b32 v65, s9, v36
    v_lshlrev_b32 v66, 16, v37
    v_and_b32 v67, s9, v37
    v_lshlrev_b32 v68, 16, v38
    v_and_b32 v69, s9, v38
    v_lshlrev_b32 v70, 16, v39
    v_and_b32 v71, s9, v39
    v_lshlrev_b32 v72, 16, v40
    v_and_b32 v73, s9, v40
    v_lshlrev_b32 v74, 16, v41
    v_and_b32 v75, s9, v41
    v_lshlrev_b32 v76, 16, v42
    v_and_b32 v77, s9, v42
    v_lshlrev_b32 v78, 16, v43
    v_and_b32 v79, s9, v43
    v_lshlrev_b32 v80, 16, v44
    v_and_b32 v81, s9, v44
    v_lshlrev_b32 v82, 16, v45
    v_and_b32 v83, s9, v45
    v_lshlrev_b32 v84, 16, v46
    v_and_b32 v85, s9, v46
    v_lshlrev_b32 v86, 16, v47
    v_and_b32 v87, s9, v47
    v_lshlrev_b32 v88, 16, v48
    v_and_b32 v89, s9, v48
    v_lshlrev_b32 v90, 16, v49
    v_and_b32 v91, s9, v49
    v_lshlrev_b32 v92, 16, v50
    v_and_b32 v93, s9, v50
    v_lshlrev_b32 v94, 16, v51
    v_and_b32 v95, s9, v51
    v_pk_mul_f32 v[112:113], v[112:113], v[64:65]
    v_pk_mul_f32 v[114:115], v[114:115], v[66:67]
    v_pk_mul_f32 v[116:117], v[116:117], v[68:69]
    v_pk_mul_f32 v[118:119], v[118:119], v[70:71]
    v_pk_mul_f32 v[120:121], v[120:121], v[72:73]
    v_pk_mul_f32 v[122:123], v[122:123], v[74:75]
    v_pk_mul_f32 v[124:125], v[124:125], v[76:77]
    v_pk_mul_f32 v[126:127], v[126:127], v[78:79]
    v_pk_mul_f32 v[128:129], v[128:129], v[80:81]
    v_pk_mul_f32 v[130:131], v[130:131], v[82:83]
    v_pk_mul_f32 v[132:133], v[132:133], v[84:85]
    v_pk_mul_f32 v[134:135], v[134:135], v[86:87]
    v_pk_mul_f32 v[136:137], v[136:137], v[88:89]
    v_pk_mul_f32 v[138:139], v[138:139], v[90:91]
    v_pk_mul_f32 v[140:141], v[140:141], v[92:93]
    v_pk_mul_f32 v[142:143], v[142:143], v[94:95]
    v_cvt_pk_bf16_f32 v148, v126, v124
    v_cvt_pk_bf16_f32 v149, v122, v120
    v_cvt_pk_bf16_f32 v150, v118, v116
    v_cvt_pk_bf16_f32 v151, v114, v112
    ds_write_b128 v12, v[148:151] offset:0
    v_cvt_pk_bf16_f32 v152, v142, v140
    v_cvt_pk_bf16_f32 v153, v138, v136
    v_cvt_pk_bf16_f32 v154, v134, v132
    v_cvt_pk_bf16_f32 v155, v130, v128
    ds_write_b128 v13, v[152:155] offset:0
    v_cvt_pk_bf16_f32 v156, v127, v125
    v_cvt_pk_bf16_f32 v157, v123, v121
    v_cvt_pk_bf16_f32 v158, v119, v117
    v_cvt_pk_bf16_f32 v159, v115, v113
    ds_write_b128 v12, v[156:159] offset:35328
    v_cvt_pk_bf16_f32 v160, v143, v141
    v_cvt_pk_bf16_f32 v161, v139, v137
    v_cvt_pk_bf16_f32 v162, v135, v133
    v_cvt_pk_bf16_f32 v163, v131, v129
    ds_write_b128 v13, v[160:163] offset:35328
    v_lshrrev_b32 v14, 5, v0
    v_and_b32 v15, 31, v0
    v_mul_u32_u24 v12, 528, v14
    v_lshl_add_u32 v12, v15, 4, v12
    v_add_u32 v12, 8448, v12
    s_lshl_b32 s8, s5, 18
    s_lshl_b32 s9, s4, 9
    s_sub_u32 s8, s8, s9
    s_add_u32 s8, s8, 3584
    v_lshlrev_b32 v13, 13, v14
    v_lshl_add_u32 v13, v15, 4, v13
    v_add_u32 v13, s8, v13
    s_waitcnt lgkmcnt(0)
    s_barrier
    ds_read_b128 v[64:67], v12 offset:0
    ds_read_b128 v[68:71], v12 offset:17664
    ds_read_b128 v[72:75], v12 offset:35328
    ds_read_b128 v[76:79], v12 offset:52992
    s_mov_b32 s9, 0
    s_waitcnt lgkmcnt(3)
    buffer_store_dwordx4 v[64:67], v13, s[56:59], s9 offen sc1
    s_mov_b32 s9, 131072
    s_waitcnt lgkmcnt(2)
    buffer_store_dwordx4 v[68:71], v13, s[56:59], s9 offen sc1
    s_mov_b32 s9, 4096
    s_waitcnt lgkmcnt(1)
    buffer_store_dwordx4 v[72:75], v13, s[56:59], s9 offen sc1
    s_mov_b32 s9, 135168
    s_waitcnt lgkmcnt(0)
    buffer_store_dwordx4 v[76:79], v13, s[56:59], s9 offen sc1
    s_mov_b32 s56, s36
    s_and_b32 s57, s37, 0xffff
    s_mov_b32 s58, 256
    s_mov_b32 s59, 0x00020000
    v_mov_b32 v252, 248
    buffer_load_dwordx2 v[250:251], v252, s[56:59], 0 offen sc1
    s_add_u32 s52, s38, 10485760
    s_addc_u32 s53, s39, 0
    s_and_b32 s53, s53, 0xffff
    s_mov_b32 s54, 8192
    s_mov_b32 s55, 0x00020000
    s_lshl_b32 s69, s5, 7
    s_lshl_b32 s9, s4, 3
    s_add_u32 s69, s69, s9
    s_add_u32 s69, s69, 4096
    v_lshrrev_b32 v1, 6, v0
    v_and_b32 v2, 63, v0
    s_and_b32 s7, s3, 7
    v_readfirstlane_b32 s6, v1
    s_mul_i32 s7, s7, 72
    s_lshr_b32 s8, s3, 3
    s_lshl_b32 s8, s8, 3
    s_add_u32 s7, s7, s8
    s_add_u32 s8, s7, s6
    s_mul_i32 s10, s6, 17664
    s_waitcnt vmcnt(0)
    s_barrier
    s_cmp_lg_u32 s6, 0
    s_cbranch_scc1 F_BH
    v_readfirstlane_b32 s66, v250
    v_readfirstlane_b32 s67, v251
    s_nop 3
    s_cmp_lg_u32 s66, 0
    s_cbranch_scc1 Ltagok_25
    s_mov_b32 s56, s36
    s_and_b32 s57, s37, 0xffff
    s_mov_b32 s58, 256
    s_mov_b32 s59, 0x00020000
    v_mov_b32 v252, 248
    s_mov_b32 s68, 0
Ltagpoll_26:
    buffer_load_dwordx2 v[250:251], v252, s[56:59], 0 offen sc1
    s_waitcnt vmcnt(0)
    v_readfirstlane_b32 s66, v250
    v_readfirstlane_b32 s67, v251
    s_add_u32 s68, s68, 1
    s_cmp_lg_u32 s66, 0
    s_cbranch_scc1 Ltagdone_27
    s_cmp_ge_u32 s68, 0x20000
    s_cbranch_scc1 Ltagdone_27
    s_sleep 1
    s_branch Ltagpoll_26
Ltagdone_27:
Ltagok_25:
    v_mov_b32 v250, s66
    v_mov_b32 v251, s67
    v_mov_b32 v252, s69
    s_mov_b64 s[62:63], exec
    s_mov_b64 exec, 1
    buffer_store_dwordx2 v[250:251], v252, s[52:55], 0 offen sc1
    s_mov_b64 exec, s[62:63]
F_BH:
    s_lshl_b32 s9, s8, 12
    s_add_u32 s44, s30, s9
    s_addc_u32 s45, s31, 0
    s_and_b32 s45, s45, 0xffff
    s_mov_b32 s46, 4096
    s_mov_b32 s47, 0x00020000
    v_lshlrev_b32 v3, 4, v2
    v_add_u32 v4, 8, v3
    v_add_u32 v5, 4, v3
    s_add_u32 m0, s10, 64
    s_mov_b32 s9, 0
    buffer_load_dwordx4 v5, s[44:47], s9 offen lds
    s_add_u32 m0, s10, 4288
    s_nop 0
    buffer_load_dwordx4 v4, s[44:47], s9 offen lds
    s_add_u32 m0, s10, 1088
    s_mov_b32 s9, 1024
    buffer_load_dwordx4 v5, s[44:47], s9 offen lds
    s_add_u32 m0, s10, 5312
    s_nop 0
    buffer_load_dwordx4 v4, s[44:47], s9 offen lds
    s_add_u32 m0, s10, 2112
    s_mov_b32 s9, 2048
    buffer_load_dwordx4 v5, s[44:47], s9 offen lds
    s_add_u32 m0, s10, 6336
    s_nop 0
    buffer_load_dwordx4 v4, s[44:47], s9 offen lds
    s_add_u32 m0, s10, 3136
    s_mov_b32 s9, 3072
    buffer_load_dwordx4 v5, s[44:47], s9 offen lds
    s_add_u32 m0, s10, 7360
    s_nop 0
    buffer_load_dwordx4 v4, s[44:47], s9 offen lds
    v_mov_b32 v6, 0
    buffer_load_dwordx2 v[8:9], v6, s[44:47], 0 offen
    s_cmp_lg_u32 s6, 0
    s_cbranch_scc1 F_BW
    s_lshr_b32 s69, s7, 6
    s_lshl_b32 s69, s69, 7
    s_add_u32 s69, s69, 4096
    s_mov_b64 s[62:63], exec
    s_mov_b64 exec, 0xff
    v_lshlrev_b32 v252, 3, v0
    v_add_u32 v252, s69, v252
    s_mov_b32 s68, 0
    buffer_load_dwordx2 v[250:251], v252, s[52:55], 0 offen sc1
Lfpoll_28:
    s_sleep 2
    buffer_load_dwordx2 v[254:255], v252, s[52:55], 0 offen sc1
    s_waitcnt vmcnt(1)
    v_cmp_eq_u32 vcc, s66, v250
    v_cmp_eq_u32 s[64:65], s67, v251
    s_add_u32 s68, s68, 1
    s_and_b64 vcc, vcc, s[64:65]
    s_cmp_eq_u32 vcc_lo, 0xff
    s_cbranch_scc1 Lfdone_29
    s_sleep 2
    buffer_load_dwordx2 v[250:251], v252, s[52:55], 0 offen sc1
    s_waitcnt vmcnt(1)
    v_cmp_eq_u32 vcc, s66, v254
    v_cmp_eq_u32 s[64:65], s67, v255
    s_add_u32 s68, s68, 1
    s_and_b64 vcc, vcc, s[64:65]
    s_cmp_eq_u32 vcc_lo, 0xff
    s_cbranch_scc1 Lfdone_29
    s_cmp_ge_u32 s68, 0x20000
    s_cbranch_scc0 Lfpoll_28
Lfdone_29:
    s_mov_b64 exec, s[62:63]
Lfskip_30:
F_BW:
    s_waitcnt vmcnt(0)
    v_mov_b32 v10, 0
    v_mov_b32 v11, 0
    v_cmp_eq_u32 vcc, 14, v2
    v_cmp_eq_u32 s[60:61], 15, v2
    v_lshlrev_b32 v12, 2, v2
    v_cndmask_b32 v10, v10, v8, vcc
    v_add_u32 v12, s10, v12
    v_cndmask_b32_e64 v10, v10, v9, s[60:61]
    v_cndmask_b32_e64 v11, v11, v8, s[60:61]
    s_mov_b64 s[62:63], exec
    s_mov_b64 exec, 0xffff
    ds_write_b32 v12, v10 offset:4224
    ds_write_b32 v12, v11
    s_mov_b64 exec, 0xfffffff
    v_mov_b32 v8, 0
    v_mov_b32 v9, 0
    v_mov_b32 v10, 0
    v_mov_b32 v11, 0
    v_lshlrev_b32 v12, 4, v2
    v_add_u32 v12, s10, v12
    ds_write_b128 v12, v[8:11] offset:12544
    ds_write_b128 v12, v[8:11] offset:17104
    s_mov_b64 exec, s[62:63]
    s_barrier
    s_lshl_b32 s9, s8, 12
    s_add_u32 s9, s9, 4194304
    s_add_u32 s40, s38, s9
    s_addc_u32 s41, s39, 0
    s_and_b32 s41, s41, 0xffff
    s_mov_b32 s42, 4096
    s_mov_b32 s43, 0x00020000
    v_lshlrev_b32 v3, 4, v2
    s_mov_b32 s9, 0
    buffer_load_dwordx4 v[16:19], v3, s[40:43], s9 offen sc1
    buffer_load_dword v20, v3, s[40:43], s9 offen offset:16 sc1
    s_mov_b32 s9, 1024
    buffer_load_dwordx4 v[22:25], v3, s[40:43], s9 offen sc1
    buffer_load_dword v26, v3, s[40:43], s9 offen offset:16 sc1
    s_mov_b32 s9, 2048
    buffer_load_dwordx4 v[28:31], v3, s[40:43], s9 offen sc1
    buffer_load_dword v32, v3, s[40:43], s9 offen offset:16 sc1
    s_mov_b32 s9, 3072
    buffer_load_dwordx4 v[34:37], v3, s[40:43], s9 offen sc1
    buffer_load_dword v38, v3, s[40:43], s9 offen offset:16 sc1
    s_mov_b32 s48, s22
    s_and_b32 s49, s23, 0xffff
    s_mov_b32 s50, 2359296
    s_mov_b32 s51, 0x00020000
    v_mul_u32_u24 v13, 1152, v0
    s_lshl_b32 s12, s7, 1
    v_add_u32 v13, s12, v13
    s_mov_b32 s13, 0
    buffer_load_dwordx4 v[232:235], v13, s[48:51], s13 offen
    s_mov_b32 s13, 589824
    buffer_load_dwordx4 v[236:239], v13, s[48:51], s13 offen
    s_mov_b32 s13, 1179648
    buffer_load_dwordx4 v[240:243], v13, s[48:51], s13 offen
    s_mov_b32 s13, 1769472
    buffer_load_dwordx4 v[244:247], v13, s[48:51], s13 offen
    s_load_dwordx4 s[56:59], s[32:33], s12
    v_add_u32 v4, s10, v3
    v_and_b32 v10, 1, v2
    v_mul_u32_u24 v10, 4224, v10
    v_bfe_u32 v11, v2, 1, 3
    v_lshrrev_b32 v12, 4, v2
    v_lshl_add_u32 v11, v12, 2, v11
    v_lshl_add_u32 v10, v11, 3, v10
    v_add_u32 v10, s10, v10
    v_and_b32 v11, 1, v2
    v_mul_u32_u24 v11, 4560, v11
    v_bfe_u32 v13, v2, 1, 3
    v_lshlrev_b32 v13, 2, v13
    v_lshlrev_b32 v12, 1, v12
    v_sub_u32 v12, v12, v13
    v_add_u32 v12, 28, v12
    v_lshl_add_u32 v11, v12, 4, v11
    s_add_u32 s9, s10, 8448
    v_add_u32 v11, s9, v11
    s_waitcnt vmcnt(10)
    ds_write_b128 v4, v[16:19] offset:13008
    v_alignbit_b32 v40, v17, v16, 16
    v_alignbit_b32 v41, v18, v17, 16
    v_alignbit_b32 v42, v19, v18, 16
    v_alignbit_b32 v43, v20, v19, 16
    ds_write_b128 v4, v[40:43] offset:8448
    s_waitcnt vmcnt(8)
    ds_write_b128 v4, v[22:25] offset:14032
    v_alignbit_b32 v44, v23, v22, 16
    v_alignbit_b32 v45, v24, v23, 16
    v_alignbit_b32 v46, v25, v24, 16
    v_alignbit_b32 v47, v26, v25, 16
    ds_write_b128 v4, v[44:47] offset:9472
    s_waitcnt vmcnt(6)
    ds_write_b128 v4, v[28:31] offset:15056
    v_alignbit_b32 v40, v29, v28, 16
    v_alignbit_b32 v41, v30, v29, 16
    v_alignbit_b32 v42, v31, v30, 16
    v_alignbit_b32 v43, v32, v31, 16
    ds_write_b128 v4, v[40:43] offset:10496
    s_waitcnt vmcnt(4)
    ds_write_b128 v4, v[34:37] offset:16080
    v_alignbit_b32 v44, v35, v34, 16
    v_alignbit_b32 v45, v36, v35, 16
    v_alignbit_b32 v46, v37, v36, 16
    v_alignbit_b32 v47, v38, v37, 16
    ds_write_b128 v4, v[44:47] offset:11520
    s_waitcnt lgkmcnt(0)
    ds_read_b64 v[48:49], v10 offset:0
    ds_read_b64 v[50:51], v10 offset:8
    ds_read_b128 v[80:83], v11 offset:3584
    ds_read_b64 v[52:53], v10 offset:512
    ds_read_b64 v[54:55], v10 offset:520
    ds_read_b128 v[84:87], v11 offset:3072
    ds_read_b64 v[56:57], v10 offset:1024
    ds_read_b64 v[58:59], v10 offset:1032
    ds_read_b128 v[88:91], v11 offset:2560
    ds_read_b64 v[60:61], v10 offset:1536
    ds_read_b64 v[62:63], v10 offset:1544
    ds_read_b128 v[92:95], v11 offset:2048
    ds_read_b64 v[64:65], v10 offset:2048
    ds_read_b64 v[66:67], v10 offset:2056
    ds_read_b128 v[96:99], v11 offset:1536
    ds_read_b64 v[68:69], v10 offset:2560
    ds_read_b64 v[70:71], v10 offset:2568
    ds_read_b128 v[100:103], v11 offset:1024
    ds_read_b64 v[72:73], v10 offset:3072
    ds_read_b64 v[74:75], v10 offset:3080
    ds_read_b128 v[104:107], v11 offset:512
    ds_read_b64 v[76:77], v10 offset:3584
    ds_read_b64 v[78:79], v10 offset:3592
    ds_read_b128 v[108:111], v11 offset:0
    v_mov_b32 v16, 0
    v_mov_b32 v17, 0
    v_mov_b32 v18, 0
    v_mov_b32 v19, 0
    v_mov_b32 v20, 0
    v_mov_b32 v21, 0
    v_mov_b32 v22, 0
    v_mov_b32 v23, 0
    v_mov_b32 v24, 0
    v_mov_b32 v25, 0
    v_mov_b32 v26, 0
    v_mov_b32 v27, 0
    v_mov_b32 v28, 0
    v_mov_b32 v29, 0
    v_mov_b32 v30, 0
    v_mov_b32 v31, 0
    v_mov_b32 v32, 0
    v_mov_b32 v33, 0
    v_mov_b32 v34, 0
    v_mov_b32 v35, 0
    v_mov_b32 v36, 0
    v_mov_b32 v37, 0
    v_mov_b32 v38, 0
    v_mov_b32 v39, 0
    v_mov_b32 v40, 0
    v_mov_b32 v41, 0
    v_mov_b32 v42, 0
    v_mov_b32 v43, 0
    v_mov_b32 v44, 0
    v_mov_b32 v45, 0
    v_mov_b32 v46, 0
    v_mov_b32 v47, 0
    s_mov_b32 s9, 0
    s_waitcnt lgkmcnt(0)
B1_LOOP:
    v_mfma_f32_16x16x32_bf16 v[16:19], v[80:83], v[48:51], v[16:19]
    ds_read_b64 v[112:113], v10 offset:16
    v_mfma_f32_16x16x32_bf16 v[20:23], v[84:87], v[48:51], v[20:23]
    ds_read_b64 v[114:115], v10 offset:24
    v_mfma_f32_16x16x32_bf16 v[24:27], v[88:91], v[48:51], v[24:27]
    ds_read_b128 v[144:147], v11 offset:3600
    v_mfma_f32_16x16x32_bf16 v[28:31], v[92:95], v[48:51], v[28:31]
    ds_read_b64 v[116:117], v10 offset:528
    v_mfma_f32_16x16x32_bf16 v[32:35], v[96:99], v[48:51], v[32:35]
    ds_read_b64 v[118:119], v10 offset:536
    v_mfma_f32_16x16x32_bf16 v[36:39], v[100:103], v[48:51], v[36:39]
    ds_read_b128 v[148:151], v11 offset:3088
    v_mfma_f32_16x16x32_bf16 v[40:43], v[104:107], v[48:51], v[40:43]
    ds_read_b64 v[120:121], v10 offset:1040
    v_mfma_f32_16x16x32_bf16 v[44:47], v[108:111], v[48:51], v[44:47]
    ds_read_b64 v[122:123], v10 offset:1048
    v_mfma_f32_16x16x32_bf16 v[20:23], v[80:83], v[52:55], v[20:23]
    ds_read_b128 v[152:155], v11 offset:2576
    v_mfma_f32_16x16x32_bf16 v[24:27], v[84:87], v[52:55], v[24:27]
    ds_read_b64 v[124:125], v10 offset:1552
    v_mfma_f32_16x16x32_bf16 v[28:31], v[88:91], v[52:55], v[28:31]
    ds_read_b64 v[126:127], v10 offset:1560
    v_mfma_f32_16x16x32_bf16 v[32:35], v[92:95], v[52:55], v[32:35]
    ds_read_b128 v[156:159], v11 offset:2064
    v_mfma_f32_16x16x32_bf16 v[36:39], v[96:99], v[52:55], v[36:39]
    ds_read_b64 v[128:129], v10 offset:2064
    v_mfma_f32_16x16x32_bf16 v[40:43], v[100:103], v[52:55], v[40:43]
    ds_read_b64 v[130:131], v10 offset:2072
    v_mfma_f32_16x16x32_bf16 v[44:47], v[104:107], v[52:55], v[44:47]
    ds_read_b128 v[160:163], v11 offset:1552
    v_mfma_f32_16x16x32_bf16 v[24:27], v[80:83], v[56:59], v[24:27]
    ds_read_b64 v[132:133], v10 offset:2576
    v_mfma_f32_16x16x32_bf16 v[28:31], v[84:87], v[56:59], v[28:31]
    ds_read_b64 v[134:135], v10 offset:2584
    v_mfma_f32_16x16x32_bf16 v[32:35], v[88:91], v[56:59], v[32:35]
    ds_read_b128 v[164:167], v11 offset:1040
    v_mfma_f32_16x16x32_bf16 v[36:39], v[92:95], v[56:59], v[36:39]
    ds_read_b64 v[136:137], v10 offset:3088
    v_mfma_f32_16x16x32_bf16 v[40:43], v[96:99], v[56:59], v[40:43]
    ds_read_b64 v[138:139], v10 offset:3096
    v_mfma_f32_16x16x32_bf16 v[44:47], v[100:103], v[56:59], v[44:47]
    ds_read_b128 v[168:171], v11 offset:528
    v_mfma_f32_16x16x32_bf16 v[28:31], v[80:83], v[60:63], v[28:31]
    ds_read_b64 v[140:141], v10 offset:3600
    v_mfma_f32_16x16x32_bf16 v[32:35], v[84:87], v[60:63], v[32:35]
    ds_read_b64 v[142:143], v10 offset:3608
    v_mfma_f32_16x16x32_bf16 v[36:39], v[88:91], v[60:63], v[36:39]
    ds_read_b128 v[172:175], v11 offset:16
    v_mfma_f32_16x16x32_bf16 v[40:43], v[92:95], v[60:63], v[40:43]
    v_mfma_f32_16x16x32_bf16 v[44:47], v[96:99], v[60:63], v[44:47]
    v_mfma_f32_16x16x32_bf16 v[32:35], v[80:83], v[64:67], v[32:35]
    v_mfma_f32_16x16x32_bf16 v[36:39], v[84:87], v[64:67], v[36:39]
    v_mfma_f32_16x16x32_bf16 v[40:43], v[88:91], v[64:67], v[40:43]
    v_mfma_f32_16x16x32_bf16 v[44:47], v[92:95], v[64:67], v[44:47]
    v_mfma_f32_16x16x32_bf16 v[36:39], v[80:83], v[68:71], v[36:39]
    v_mfma_f32_16x16x32_bf16 v[40:43], v[84:87], v[68:71], v[40:43]
    v_mfma_f32_16x16x32_bf16 v[44:47], v[88:91], v[68:71], v[44:47]
    v_mfma_f32_16x16x32_bf16 v[40:43], v[80:83], v[72:75], v[40:43]
    v_mfma_f32_16x16x32_bf16 v[44:47], v[84:87], v[72:75], v[44:47]
    v_mfma_f32_16x16x32_bf16 v[44:47], v[80:83], v[76:79], v[44:47]
    s_waitcnt lgkmcnt(0)
    v_mfma_f32_16x16x32_bf16 v[16:19], v[144:147], v[112:115], v[16:19]
    ds_read_b64 v[48:49], v10 offset:128
    v_mfma_f32_16x16x32_bf16 v[20:23], v[148:151], v[112:115], v[20:23]
    ds_read_b64 v[50:51], v10 offset:136
    v_mfma_f32_16x16x32_bf16 v[24:27], v[152:155], v[112:115], v[24:27]
    ds_read_b128 v[80:83], v11 offset:3712
    v_mfma_f32_16x16x32_bf16 v[28:31], v[156:159], v[112:115], v[28:31]
    ds_read_b64 v[52:53], v10 offset:640
    v_mfma_f32_16x16x32_bf16 v[32:35], v[160:163], v[112:115], v[32:35]
    ds_read_b64 v[54:55], v10 offset:648
    v_mfma_f32_16x16x32_bf16 v[36:39], v[164:167], v[112:115], v[36:39]
    ds_read_b128 v[84:87], v11 offset:3200
    v_mfma_f32_16x16x32_bf16 v[40:43], v[168:171], v[112:115], v[40:43]
    ds_read_b64 v[56:57], v10 offset:1152
    v_mfma_f32_16x16x32_bf16 v[44:47], v[172:175], v[112:115], v[44:47]
    ds_read_b64 v[58:59], v10 offset:1160
    v_mfma_f32_16x16x32_bf16 v[20:23], v[144:147], v[116:119], v[20:23]
    ds_read_b128 v[88:91], v11 offset:2688
    v_mfma_f32_16x16x32_bf16 v[24:27], v[148:151], v[116:119], v[24:27]
    ds_read_b64 v[60:61], v10 offset:1664
    v_mfma_f32_16x16x32_bf16 v[28:31], v[152:155], v[116:119], v[28:31]
    ds_read_b64 v[62:63], v10 offset:1672
    v_mfma_f32_16x16x32_bf16 v[32:35], v[156:159], v[116:119], v[32:35]
    ds_read_b128 v[92:95], v11 offset:2176
    v_mfma_f32_16x16x32_bf16 v[36:39], v[160:163], v[116:119], v[36:39]
    ds_read_b64 v[64:65], v10 offset:2176
    v_mfma_f32_16x16x32_bf16 v[40:43], v[164:167], v[116:119], v[40:43]
    ds_read_b64 v[66:67], v10 offset:2184
    v_mfma_f32_16x16x32_bf16 v[44:47], v[168:171], v[116:119], v[44:47]
    ds_read_b128 v[96:99], v11 offset:1664
    v_mfma_f32_16x16x32_bf16 v[24:27], v[144:147], v[120:123], v[24:27]
    ds_read_b64 v[68:69], v10 offset:2688
    v_mfma_f32_16x16x32_bf16 v[28:31], v[148:151], v[120:123], v[28:31]
    ds_read_b64 v[70:71], v10 offset:2696
    v_mfma_f32_16x16x32_bf16 v[32:35], v[152:155], v[120:123], v[32:35]
    ds_read_b128 v[100:103], v11 offset:1152
    v_mfma_f32_16x16x32_bf16 v[36:39], v[156:159], v[120:123], v[36:39]
    ds_read_b64 v[72:73], v10 offset:3200
    v_mfma_f32_16x16x32_bf16 v[40:43], v[160:163], v[120:123], v[40:43]
    ds_read_b64 v[74:75], v10 offset:3208
    v_mfma_f32_16x16x32_bf16 v[44:47], v[164:167], v[120:123], v[44:47]
    ds_read_b128 v[104:107], v11 offset:640
    v_mfma_f32_16x16x32_bf16 v[28:31], v[144:147], v[124:127], v[28:31]
    ds_read_b64 v[76:77], v10 offset:3712
    v_mfma_f32_16x16x32_bf16 v[32:35], v[148:151], v[124:127], v[32:35]
    ds_read_b64 v[78:79], v10 offset:3720
    v_mfma_f32_16x16x32_bf16 v[36:39], v[152:155], v[124:127], v[36:39]
    ds_read_b128 v[108:111], v11 offset:128
    v_mfma_f32_16x16x32_bf16 v[40:43], v[156:159], v[124:127], v[40:43]
    v_mfma_f32_16x16x32_bf16 v[44:47], v[160:163], v[124:127], v[44:47]
    v_mfma_f32_16x16x32_bf16 v[32:35], v[144:147], v[128:131], v[32:35]
    v_mfma_f32_16x16x32_bf16 v[36:39], v[148:151], v[128:131], v[36:39]
    v_mfma_f32_16x16x32_bf16 v[40:43], v[152:155], v[128:131], v[40:43]
    v_mfma_f32_16x16x32_bf16 v[44:47], v[156:159], v[128:131], v[44:47]
    v_mfma_f32_16x16x32_bf16 v[36:39], v[144:147], v[132:135], v[36:39]
    v_mfma_f32_16x16x32_bf16 v[40:43], v[148:151], v[132:135], v[40:43]
    v_mfma_f32_16x16x32_bf16 v[44:47], v[152:155], v[132:135], v[44:47]
    v_mfma_f32_16x16x32_bf16 v[40:43], v[144:147], v[136:139], v[40:43]
    v_mfma_f32_16x16x32_bf16 v[44:47], v[148:151], v[136:139], v[44:47]
    v_mfma_f32_16x16x32_bf16 v[44:47], v[144:147], v[140:143], v[44:47]
    v_add_u32 v10, 128, v10
    v_add_u32 v11, 128, v11
    s_add_u32 s9, s9, 1
    s_cmp_lt_u32 s9, 4
    s_waitcnt lgkmcnt(0)
    s_cbranch_scc1 B1_LOOP
    v_and_b32 v12, 15, v2
    v_lshrrev_b32 v13, 4, v2
    v_lshlrev_b32 v13, 8, v13
    v_lshl_add_u32 v12, v12, 3, v13
    v_add_u32 v12, s10, v12
    s_nop 2
    ds_write_b64 v12, v[16:17] offset:0
    ds_write_b64 v12, v[18:19] offset:128
    ds_write_b64 v12, v[20:21] offset:1024
    ds_write_b64 v12, v[22:23] offset:1152
    ds_write_b64 v12, v[24:25] offset:2048
    ds_write_b64 v12, v[26:27] offset:2176
    ds_write_b64 v12, v[28:29] offset:3072
    ds_write_b64 v12, v[30:31] offset:3200
    ds_write_b64 v12, v[32:33] offset:4096
    ds_write_b64 v12, v[34:35] offset:4224
    ds_write_b64 v12, v[36:37] offset:5120
    ds_write_b64 v12, v[38:39] offset:5248
    ds_write_b64 v12, v[40:41] offset:6144
    ds_write_b64 v12, v[42:43] offset:6272
    ds_write_b64 v12, v[44:45] offset:7168
    ds_write_b64 v12, v[46:47] offset:7296
    v_lshlrev_b32 v12, 2, v0
    v_add_u32 v13, 52992, v12
    v_add_u32 v14, 105984, v12
    v_lshlrev_b32 v15, 1, v0
    v_sub_u32 v15, 14030, v15
    v_add_u32 v16, 52992, v15
    v_add_u32 v17, 105984, v15
    v_mul_u32_u24 v18, 2304, v0
    s_add_u32 s12, s12, 1152
    v_add_u32 v18, s12, v18
    s_mov_b32 s52, s34
    s_and_b32 s53, s35, 0xffff
    s_mov_b32 s54, 4718592
    s_mov_b32 s55, 0x00020000
    s_waitcnt lgkmcnt(0) vmcnt(0)
    s_barrier
    s_lshl_b32 s60, s56, 16
    s_and_b32 s61, s56, 0xffff0000
    s_lshl_b32 s62, s57, 16
    s_and_b32 s63, s57, 0xffff0000
    s_lshl_b32 s64, s58, 16
    s_and_b32 s65, s58, 0xffff0000
    s_lshl_b32 s66, s59, 16
    s_and_b32 s67, s59, 0xffff0000
    s_mov_b32 s9, 0xffff0000
    ds_read_b32 v48, v12 offset:0
    ds_read_u16 v56, v15 offset:3072
    ds_read_b32 v49, v12 offset:17664
    ds_read_u16 v57, v15 offset:20736
    ds_read_b32 v50, v12 offset:35328
    ds_read_u16 v58, v15 offset:38400
    ds_read_b32 v51, v13 offset:0
    ds_read_u16 v59, v16 offset:3072
    ds_read_b32 v52, v13 offset:17664
    ds_read_u16 v60, v16 offset:20736
    ds_read_b32 v53, v13 offset:35328
    ds_read_u16 v61, v16 offset:38400
    ds_read_b32 v54, v14 offset:0
    ds_read_u16 v62, v17 offset:3072
    ds_read_b32 v55, v14 offset:17664
    ds_read_u16 v63, v17 offset:20736
    ds_read_b32 v72, v12 offset:2048
    ds_read_u16 v80, v15 offset:2048
    ds_read_b32 v73, v12 offset:19712
    ds_read_u16 v81, v15 offset:19712
    ds_read_b32 v74, v12 offset:37376
    ds_read_u16 v82, v15 offset:37376
    ds_read_b32 v75, v13 offset:2048
    ds_read_u16 v83, v16 offset:2048
    ds_read_b32 v76, v13 offset:19712
    ds_read_u16 v84, v16 offset:19712
    ds_read_b32 v77, v13 offset:37376
    ds_read_u16 v85, v16 offset:37376
    ds_read_b32 v78, v14 offset:2048
    ds_read_u16 v86, v17 offset:2048
    ds_read_b32 v79, v14 offset:19712
    ds_read_u16 v87, v17 offset:19712
    ds_read_b32 v96, v12 offset:4096
    ds_read_u16 v104, v15 offset:1024
    ds_read_b32 v97, v12 offset:21760
    ds_read_u16 v105, v15 offset:18688
    ds_read_b32 v98, v12 offset:39424
    ds_read_u16 v106, v15 offset:36352
    ds_read_b32 v99, v13 offset:4096
    ds_read_u16 v107, v16 offset:1024
    ds_read_b32 v100, v13 offset:21760
    ds_read_u16 v108, v16 offset:18688
    ds_read_b32 v101, v13 offset:39424
    ds_read_u16 v109, v16 offset:36352
    ds_read_b32 v102, v14 offset:4096
    ds_read_u16 v110, v17 offset:1024
    ds_read_b32 v103, v14 offset:21760
    ds_read_u16 v111, v17 offset:18688
    ds_read_b32 v120, v12 offset:6144
    ds_read_u16 v128, v15 offset:0
    ds_read_b32 v121, v12 offset:23808
    ds_read_u16 v129, v15 offset:17664
    ds_read_b32 v122, v12 offset:41472
    ds_read_u16 v130, v15 offset:35328
    ds_read_b32 v123, v13 offset:6144
    ds_read_u16 v131, v16 offset:0
    ds_read_b32 v124, v13 offset:23808
    ds_read_u16 v132, v16 offset:17664
    ds_read_b32 v125, v13 offset:41472
    ds_read_u16 v133, v16 offset:35328
    ds_read_b32 v126, v14 offset:6144
    ds_read_u16 v134, v17 offset:0
    ds_read_b32 v127, v14 offset:23808
    ds_read_u16 v135, v17 offset:17664
    s_waitcnt lgkmcnt(15)
    v_lshlrev_b32 v56, 16, v56
    v_lshlrev_b32 v57, 16, v57
    v_lshlrev_b32 v58, 16, v58
    v_lshlrev_b32 v59, 16, v59
    v_lshlrev_b32 v60, 16, v60
    v_lshlrev_b32 v61, 16, v61
    v_lshlrev_b32 v62, 16, v62
    v_lshlrev_b32 v63, 16, v63
    v_fmac_f32 v48, s60, v56
    v_fmac_f32 v49, s61, v57
    v_fmac_f32 v50, s62, v58
    v_fmac_f32 v51, s63, v59
    v_fmac_f32 v52, s64, v60
    v_fmac_f32 v53, s65, v61
    v_fmac_f32 v54, s66, v62
    v_fmac_f32 v55, s67, v63
    v_lshlrev_b32 v56, 16, v232
    v_and_b32 v57, s9, v232
    v_lshlrev_b32 v58, 16, v233
    v_and_b32 v59, s9, v233
    v_lshlrev_b32 v60, 16, v234
    v_and_b32 v61, s9, v234
    v_lshlrev_b32 v62, 16, v235
    v_and_b32 v63, s9, v235
    v_mul_f32 v48, v48, v56
    v_mul_f32 v49, v49, v57
    v_mul_f32 v50, v50, v58
    v_mul_f32 v51, v51, v59
    v_mul_f32 v52, v52, v60
    v_mul_f32 v53, v53, v61
    v_mul_f32 v54, v54, v62
    v_mul_f32 v55, v55, v63
    v_cvt_pk_bf16_f32 v64, v48, v49
    v_cvt_pk_bf16_f32 v65, v50, v51
    v_cvt_pk_bf16_f32 v66, v52, v53
    v_cvt_pk_bf16_f32 v67, v54, v55
    s_mov_b32 s13, 0
    buffer_store_dwordx4 v[64:67], v18, s[52:55], s13 offen
    s_waitcnt lgkmcnt(15)
    v_lshlrev_b32 v80, 16, v80
    v_lshlrev_b32 v81, 16, v81
    v_lshlrev_b32 v82, 16, v82
    v_lshlrev_b32 v83, 16, v83
    v_lshlrev_b32 v84, 16, v84
    v_lshlrev_b32 v85, 16, v85
    v_lshlrev_b32 v86, 16, v86
    v_lshlrev_b32 v87, 16, v87
    v_fmac_f32 v72, s60, v80
    v_fmac_f32 v73, s61, v81
    v_fmac_f32 v74, s62, v82
    v_fmac_f32 v75, s63, v83
    v_fmac_f32 v76, s64, v84
    v_fmac_f32 v77, s65, v85
    v_fmac_f32 v78, s66, v86
    v_fmac_f32 v79, s67, v87
    v_lshlrev_b32 v80, 16, v236
    v_and_b32 v81, s9, v236
    v_lshlrev_b32 v82, 16, v237
    v_and_b32 v83, s9, v237
    v_lshlrev_b32 v84, 16, v238
    v_and_b32 v85, s9, v238
    v_lshlrev_b32 v86, 16, v239
    v_and_b32 v87, s9, v239
    v_mul_f32 v72, v72, v80
    v_mul_f32 v73, v73, v81
    v_mul_f32 v74, v74, v82
    v_mul_f32 v75, v75, v83
    v_mul_f32 v76, v76, v84
    v_mul_f32 v77, v77, v85
    v_mul_f32 v78, v78, v86
    v_mul_f32 v79, v79, v87
    v_cvt_pk_bf16_f32 v88, v72, v73
    v_cvt_pk_bf16_f32 v89, v74, v75
    v_cvt_pk_bf16_f32 v90, v76, v77
    v_cvt_pk_bf16_f32 v91, v78, v79
    s_mov_b32 s13, 1179648
    buffer_store_dwordx4 v[88:91], v18, s[52:55], s13 offen
    s_waitcnt lgkmcnt(15)
    v_lshlrev_b32 v104, 16, v104
    v_lshlrev_b32 v105, 16, v105
    v_lshlrev_b32 v106, 16, v106
    v_lshlrev_b32 v107, 16, v107
    v_lshlrev_b32 v108, 16, v108
    v_lshlrev_b32 v109, 16, v109
    v_lshlrev_b32 v110, 16, v110
    v_lshlrev_b32 v111, 16, v111
    v_fmac_f32 v96, s60, v104
    v_fmac_f32 v97, s61, v105
    v_fmac_f32 v98, s62, v106
    v_fmac_f32 v99, s63, v107
    v_fmac_f32 v100, s64, v108
    v_fmac_f32 v101, s65, v109
    v_fmac_f32 v102, s66, v110
    v_fmac_f32 v103, s67, v111
    v_lshlrev_b32 v104, 16, v240
    v_and_b32 v105, s9, v240
    v_lshlrev_b32 v106, 16, v241
    v_and_b32 v107, s9, v241
    v_lshlrev_b32 v108, 16, v242
    v_and_b32 v109, s9, v242
    v_lshlrev_b32 v110, 16, v243
    v_and_b32 v111, s9, v243
    v_mul_f32 v96, v96, v104
    v_mul_f32 v97, v97, v105
    v_mul_f32 v98, v98, v106
    v_mul_f32 v99, v99, v107
    v_mul_f32 v100, v100, v108
    v_mul_f32 v101, v101, v109
    v_mul_f32 v102, v102, v110
    v_mul_f32 v103, v103, v111
    v_cvt_pk_bf16_f32 v112, v96, v97
    v_cvt_pk_bf16_f32 v113, v98, v99
    v_cvt_pk_bf16_f32 v114, v100, v101
    v_cvt_pk_bf16_f32 v115, v102, v103
    s_mov_b32 s13, 2359296
    buffer_store_dwordx4 v[112:115], v18, s[52:55], s13 offen
    s_waitcnt lgkmcnt(0)
    v_lshlrev_b32 v128, 16, v128
    v_lshlrev_b32 v129, 16, v129
    v_lshlrev_b32 v130, 16, v130
    v_lshlrev_b32 v131, 16, v131
    v_lshlrev_b32 v132, 16, v132
    v_lshlrev_b32 v133, 16, v133
    v_lshlrev_b32 v134, 16, v134
    v_lshlrev_b32 v135, 16, v135
    v_fmac_f32 v120, s60, v128
    v_fmac_f32 v121, s61, v129
    v_fmac_f32 v122, s62, v130
    v_fmac_f32 v123, s63, v131
    v_fmac_f32 v124, s64, v132
    v_fmac_f32 v125, s65, v133
    v_fmac_f32 v126, s66, v134
    v_fmac_f32 v127, s67, v135
    v_lshlrev_b32 v128, 16, v244
    v_and_b32 v129, s9, v244
    v_lshlrev_b32 v130, 16, v245
    v_and_b32 v131, s9, v245
    v_lshlrev_b32 v132, 16, v246
    v_and_b32 v133, s9, v246
    v_lshlrev_b32 v134, 16, v247
    v_and_b32 v135, s9, v247
    v_mul_f32 v120, v120, v128
    v_mul_f32 v121, v121, v129
    v_mul_f32 v122, v122, v130
    v_mul_f32 v123, v123, v131
    v_mul_f32 v124, v124, v132
    v_mul_f32 v125, v125, v133
    v_mul_f32 v126, v126, v134
    v_mul_f32 v127, v127, v135
    v_cvt_pk_bf16_f32 v136, v120, v121
    v_cvt_pk_bf16_f32 v137, v122, v123
    v_cvt_pk_bf16_f32 v138, v124, v125
    v_cvt_pk_bf16_f32 v139, v126, v127
    s_mov_b32 s13, 3538944
    buffer_store_dwordx4 v[136:139], v18, s[52:55], s13 offen
    s_waitcnt vmcnt(0)
    s_endpgm
F_SPARE:
    s_cmp_ge_u32 s2, 256
    s_cbranch_scc1 F_EXIT
    s_waitcnt lgkmcnt(0)
    s_and_b32 s5, s2, 7
    s_mov_b32 s40, s30
    s_and_b32 s41, s31, 0xffff
    s_mov_b32 s42, 2359296
    s_mov_b32 s43, 0x00020000
    v_lshlrev_b32 v1, 7, v0
    s_mul_i32 s6, s5, 294912
    s_add_u32 s4, s6, 0
    buffer_load_dword v2, v1, s[40:43], s4 offen
    s_add_u32 s4, s6, 65536
    buffer_load_dword v3, v1, s[40:43], s4 offen
    s_add_u32 s4, s6, 131072
    buffer_load_dword v4, v1, s[40:43], s4 offen
    s_add_u32 s4, s6, 196608
    buffer_load_dword v5, v1, s[40:43], s4 offen
    s_add_u32 s4, s6, 262144
    v_cmp_gt_u32 vcc, 256, v0
    s_and_saveexec_b64 s[8:9], vcc
    buffer_load_dword v6, v1, s[40:43], s4 offen
    s_mov_b64 exec, -1
    s_mov_b32 s44, s20
    s_and_b32 s45, s21, 0xffff
    s_mov_b32 s46, 663552
    s_mov_b32 s47, 0x00020000
    v_lshlrev_b32 v1, 7, v0
    s_mov_b32 s4, 0
    buffer_load_dword v7, v1, s[44:47], s4 offen
    s_mov_b32 s4, 65536
    buffer_load_dword v8, v1, s[44:47], s4 offen
    s_mov_b32 s4, 131072
    buffer_load_dword v9, v1, s[44:47], s4 offen
    s_mov_b32 s4, 196608
    buffer_load_dword v10, v1, s[44:47], s4 offen
    s_mov_b32 s4, 262144
    buffer_load_dword v11, v1, s[44:47], s4 offen
    s_mov_b32 s4, 327680
    buffer_load_dword v12, v1, s[44:47], s4 offen
    s_mov_b32 s4, 393216
    buffer_load_dword v13, v1, s[44:47], s4 offen
    s_mov_b32 s4, 458752
    buffer_load_dword v14, v1, s[44:47], s4 offen
    s_mov_b32 s4, 524288
    buffer_load_dword v15, v1, s[44:47], s4 offen
    s_mov_b32 s4, 589824
    buffer_load_dword v16, v1, s[44:47], s4 offen
    s_mov_b32 s4, 655360
    buffer_load_dword v17, v1, s[44:47], s4 offen
    s_waitcnt vmcnt(0)
F_EXIT:
    s_endpgm
.section .rodata,"a"
.p2align 6
.amdhsa_kernel concat_heads__sliding_local_dilated__ssm_conv_h3__prompt_kernel
  .amdhsa_next_free_vgpr 256
  .amdhsa_next_free_sgpr 102
  .amdhsa_accum_offset 256
  .amdhsa_group_segment_fixed_size 0
  .amdhsa_kernarg_size 96
  .amdhsa_user_sgpr_count 2
  .amdhsa_user_sgpr_kernarg_segment_ptr 1
  .amdhsa_system_sgpr_workgroup_id_x 1
  .amdhsa_float_denorm_mode_32 3
.end_amdhsa_kernel
```
